```python
import torch

def _softmax(x, axis=-1):
    return torch.softmax(x, dim=axis)
def _gelu(x):
    return torch.nn.functional.gelu(x, approximate="tanh")
def _silu(x):
    return torch.nn.functional.silu(x)
def _sigmoid(x):
    return torch.sigmoid(x)
def _layernorm(x, axis=-1, eps=1e-5):
    m = x.mean(dim=axis, keepdim=True)
    v = x.var(dim=axis, keepdim=True, unbiased=False)
    return (x - m) / torch.sqrt(v + eps)
def _scatter_add(tgt, idx, src, axis=0):
    return tgt.clone().index_add_(axis, idx, src)
def _segment_sum(src, seg, n):
    out = torch.zeros((n,) + src.shape[1:], dtype=src.dtype)
    return out.index_add_(0, seg, src)
def _pad(x, pw):
    flat = tuple(v for pair in reversed(pw) for v in pair)
    return torch.nn.functional.pad(x, flat)

kernel_name = 'parallel_sum__grouped_kv_mqa__swiglu_ffn__prompt'

def setup_inputs():

    _w = (lambda a: (lambda t: t.to(torch.bfloat16) if t.is_floating_point() else t)(torch.as_tensor(a)))
    def _A_setup():
        B, S, D, H = 1, 2048, 640, 32
        Dh = D // H
        return {
            "x": _w((lambda *s: torch.randn(*s, dtype=torch.bfloat16) * 0.05)(B, S, D)),
            "wq": _w((lambda *s: torch.randn(*s, dtype=torch.bfloat16) * 0.2)(D, H * Dh)),
            "wk": _w((lambda *s: torch.randn(*s, dtype=torch.bfloat16) * 0.2)(D, Dh)),
            "wv": _w((lambda *s: torch.randn(*s, dtype=torch.bfloat16) * 0.1)(D, Dh)),
            "wo": _w((lambda *s: torch.randn(*s, dtype=torch.bfloat16) * 0.1)(H * Dh, D)),
        }
    _A_in = _A_setup()

    def _B_setup():
        B, S, D, F = 1, 2048, 640, 1536
        return {
            "x": _w((lambda *s: torch.randn(*s, dtype=torch.bfloat16) * 0.05)(B, S, D)),
            "w_gate": _w((lambda *s: torch.randn(*s, dtype=torch.bfloat16) * 0.1)(D, F)),
            "w_up": _w((lambda *s: torch.randn(*s, dtype=torch.bfloat16) * 0.1)(D, F)),
            "w_down": _w((lambda *s: torch.randn(*s, dtype=torch.bfloat16) * 0.1)(F, D)),
        }
    _B_in = _B_setup()

    return {
        "A_x": _A_in["x"],
        "A_wq": _A_in["wq"],
        "A_wk": _A_in["wk"],
        "A_wv": _A_in["wv"],
        "A_wo": _A_in["wo"],
        "B_x": _B_in["x"],
        "B_w_gate": _B_in["w_gate"],
        "B_w_up": _B_in["w_up"],
        "B_w_down": _B_in["w_down"],
    }

def reference(A_x, A_wq, A_wk, A_wv, A_wo, B_x, B_w_gate, B_w_up, B_w_down):
    def _A_ref(x, wq, wk, wv, wo):
        B, S, D = x.shape
        H = 32
        Dh = D // H
        q = (lambda x, *d: x.permute(*d))((x @ wq).reshape(B, S, H, Dh), 0, 2, 1, 3)
        k = x @ wk
        v = x @ wv
        scores = torch.einsum("bhqd,bkd->bhqk", q, k) * (Dh ** -0.5)
        p = _softmax(scores, axis=-1)
        o = torch.einsum("bhqk,bkd->bhqd", p, v)
        return (lambda x, *d: x.permute(*d))(o, 0, 2, 1, 3).reshape(B, S, H * Dh) @ wo

    def _B_ref(x, w_gate, w_up, w_down):
        g = _silu(x @ w_gate)
        u = x @ w_up
        return (g * u) @ w_down

    x = A_x
    xn = _layernorm(x, axis=-1)
    return x + _A_ref(xn, A_wq, A_wk, A_wv, A_wo) + _B_ref(xn, B_w_gate, B_w_up, B_w_down)
```

```asm
; @launch grid=(512,1,1) block=(256,1,1) lds=81920
.amdgcn_target "amdgcn-amd-amdhsa--gfx950"
.text
.globl parallel_sum__grouped_kv_mqa__swiglu_ffn__prompt_kernel
.p2align 8
.type parallel_sum__grouped_kv_mqa__swiglu_ffn__prompt_kernel,@function
parallel_sum__grouped_kv_mqa__swiglu_ffn__prompt_kernel:
  s_load_dwordx16 s[48:63], s[0:1], 0
  s_load_dwordx8 s[64:71], s[0:1], 64
  v_and_b32 v1, 63, v0
  v_lshrrev_b32 v2, 6, v0
  s_nop 0
  v_readfirstlane_b32 s3, v2
  v_lshlrev_b32 v2, 4, v1
  s_cmp_lt_u32 s2, 256
  s_cbranch_scc1 parallel_sum__grouped_kv_mqa__swiglu_ffn__prompt_kernel_roleB2
  s_cmp_lt_u32 s2, 512
  s_cbranch_scc1 parallel_sum__grouped_kv_mqa__swiglu_ffn__prompt_kernel_go3
  s_endpgm
parallel_sum__grouped_kv_mqa__swiglu_ffn__prompt_kernel_go3:
  s_sub_u32 s2, s2, 256
  s_setprio 2
  s_bfe_u32 s8, s2, 0x20001
  s_lshl_b32 s8, s8, 3
  s_lshr_b32 s9, s2, 5
  s_add_u32 s8, s8, s9
  s_and_b32 s9, s2, 1
  s_lshl_b32 s9, s9, 2
  s_bfe_u32 s32, s2, 0x20003
  s_add_u32 s9, s9, s32
  s_add_u32 s11, s8, s9
  s_mul_i32 s11, s11, 3
  s_mul_i32 s32, s11, 205
  s_lshr_b32 s32, s32, 11
  s_mul_i32 s32, s32, 10
  s_sub_u32 s11, s11, s32
  v_lshrrev_b32 v3, 3, v1
  v_mul_u32_u24 v3, 1280, v3
  v_and_b32 v4, 7, v1
  v_lshrrev_b32 v5, 4, v1
  v_xor_b32 v4, v4, v5
  v_lshl_add_u32 v21, v4, 4, v3
  v_xor_b32 v22, 64, v21
  v_add_u32 v3, 0, v1
  v_mul_u32_u24 v4, 6554, v3
  v_lshrrev_b32 v4, 16, v4
  v_mul_u32_u24 v5, 10, v4
  v_sub_u32 v5, v3, v5
  v_and_b32 v3, 24, v4
  v_bfe_u32 v6, v4, 1, 2
  v_add_u32 v3, v3, v6
  v_and_b32 v6, 1, v4
  v_lshl_add_u32 v3, v6, 2, v3
  v_mul_u32_u24 v3, 1280, v3
  v_lshl_add_u32 v16, v5, 4, v3
  v_add_u32 v3, 64, v1
  v_mul_u32_u24 v4, 6554, v3
  v_lshrrev_b32 v4, 16, v4
  v_mul_u32_u24 v5, 10, v4
  v_sub_u32 v5, v3, v5
  v_and_b32 v3, 24, v4
  v_bfe_u32 v6, v4, 1, 2
  v_add_u32 v3, v3, v6
  v_and_b32 v6, 1, v4
  v_lshl_add_u32 v3, v6, 2, v3
  v_mul_u32_u24 v3, 1280, v3
  v_lshl_add_u32 v17, v5, 4, v3
  v_add_u32 v3, 128, v1
  v_mul_u32_u24 v4, 6554, v3
  v_lshrrev_b32 v4, 16, v4
  v_mul_u32_u24 v5, 10, v4
  v_sub_u32 v5, v3, v5
  v_and_b32 v3, 24, v4
  v_bfe_u32 v6, v4, 1, 2
  v_add_u32 v3, v3, v6
  v_and_b32 v6, 1, v4
  v_lshl_add_u32 v3, v6, 2, v3
  v_mul_u32_u24 v3, 1280, v3
  v_lshl_add_u32 v18, v5, 4, v3
  v_add_u32 v3, 192, v1
  v_mul_u32_u24 v4, 6554, v3
  v_lshrrev_b32 v4, 16, v4
  v_mul_u32_u24 v5, 10, v4
  v_sub_u32 v5, v3, v5
  v_and_b32 v3, 24, v4
  v_bfe_u32 v6, v4, 1, 2
  v_add_u32 v3, v3, v6
  v_and_b32 v6, 1, v4
  v_lshl_add_u32 v3, v6, 2, v3
  v_mul_u32_u24 v3, 1280, v3
  v_lshl_add_u32 v19, v5, 4, v3
  v_add_u32 v3, 256, v1
  v_mul_u32_u24 v4, 6554, v3
  v_lshrrev_b32 v4, 16, v4
  v_mul_u32_u24 v5, 10, v4
  v_sub_u32 v5, v3, v5
  v_and_b32 v3, 24, v4
  v_bfe_u32 v6, v4, 1, 2
  v_add_u32 v3, v3, v6
  v_and_b32 v6, 1, v4
  v_lshl_add_u32 v3, v6, 2, v3
  v_mul_u32_u24 v3, 1280, v3
  v_lshl_add_u32 v20, v5, 4, v3
  s_mul_i32 s12, s3, 40960
  s_mul_i32 s32, s9, 160
  s_add_u32 s12, s12, s32
  s_mov_b32 s13, 81920
  s_waitcnt lgkmcnt(0)
  s_mov_b32 s20, s50
  s_mov_b32 s21, s51
  s_mov_b32 s22, 0xc8000
  s_mov_b32 s23, 0x20000
  s_mov_b64 s[18:19], -1
  s_cmp_lt_u32 s3, 2
  s_cbranch_scc1 parallel_sum__grouped_kv_mqa__swiglu_ffn__prompt_kernel_wrole4
  s_mov_b64 s[18:19], 1
  v_add_u32 v16, 0, v21
  v_add_u32 v17, 10240, v22
  v_add_u32 v18, 20480, v21
  v_add_u32 v19, 30720, v22
  v_mov_b32 v20, 0x7ff00000
  s_lshl_b32 s33, s8, 1
  s_add_u32 s33, s33, s3
  s_sub_u32 s33, s33, 2
  s_mul_i32 s12, s33, 40960
  s_mov_b32 s13, 128
  s_mov_b32 s20, s48
  s_mov_b32 s21, s49
  s_mov_b32 s22, 0x280000
  s_mov_b32 s23, 0x20000
parallel_sum__grouped_kv_mqa__swiglu_ffn__prompt_kernel_wrole4:
  s_mul_i32 s34, s11, s13
  s_add_u32 s34, s34, s12
  s_mul_i32 s35, s13, 10
  s_add_u32 s35, s35, s12
  s_mul_i32 s14, s3, 5120
  s_add_u32 m0, s14, 0
  s_nop 0
  buffer_load_dwordx4 v16, s[20:23], s34 offen lds
  s_add_u32 m0, m0, 1024
  s_nop 0
  buffer_load_dwordx4 v17, s[20:23], s34 offen lds
  s_add_u32 m0, m0, 1024
  s_nop 0
  buffer_load_dwordx4 v18, s[20:23], s34 offen lds
  s_add_u32 m0, m0, 1024
  s_nop 0
  buffer_load_dwordx4 v19, s[20:23], s34 offen lds
  s_add_u32 m0, m0, 1024
  s_mov_b64 exec, s[18:19]
  buffer_load_dwordx4 v20, s[20:23], s34 offen lds
  s_mov_b64 exec, -1
  s_add_u32 s34, s34, s13
  s_cmp_eq_u32 s34, s35
  s_cselect_b32 s34, s12, s34
  s_branch parallel_sum__grouped_kv_mqa__swiglu_ffn__prompt_kernel_roleA1
parallel_sum__grouped_kv_mqa__swiglu_ffn__prompt_kernel_roleB2:
  s_setprio 3
  s_and_b32 s5, s2, 7
  s_lshr_b32 s6, s2, 3
  s_lshl_b32 s4, s5, 4
  s_lshr_b32 s11, s6, 1
  s_add_u32 s4, s4, s11
  s_and_b32 s11, s6, 1
  s_cmp_lg_u32 s6, 31
  s_cbranch_scc1 parallel_sum__grouped_kv_mqa__swiglu_ffn__prompt_kernel_nocp7
  s_getpc_b64 s[34:35]
parallel_sum__grouped_kv_mqa__swiglu_ffn__prompt_kernel_here8:
  s_sub_u32 s34, s34, parallel_sum__grouped_kv_mqa__swiglu_ffn__prompt_kernel_here8-parallel_sum__grouped_kv_mqa__swiglu_ffn__prompt_kernel
  s_subb_u32 s35, s35, 0
  v_lshlrev_b32 v9, 7, v0
  v_min_u32 v9, parallel_sum__grouped_kv_mqa__swiglu_ffn__prompt_kernel_end-parallel_sum__grouped_kv_mqa__swiglu_ffn__prompt_kernel-4, v9
  global_load_dword v255, v9, s[34:35]
parallel_sum__grouped_kv_mqa__swiglu_ffn__prompt_kernel_nocp7:
  v_and_b32 v3, 15, v1
  v_lshrrev_b32 v4, 4, v1
  s_mul_i32 s12, s4, 20480
  s_mul_i32 s13, s3, 320
  s_add_u32 s12, s12, s13
  v_mul_u32_u24 v5, 1280, v3
  v_lshl_add_u32 v5, v4, 4, v5
  s_mul_i32 s14, s3, 6400
  s_mul_i32 s15, s3, 7168
  s_add_u32 s37, s14, 4096
  s_waitcnt lgkmcnt(0)
  s_mov_b32 s16, s48
  s_mov_b32 s17, s49
  s_mov_b32 s18, 0x280000
  s_mov_b32 s19, 0x20000
  buffer_load_dwordx4 v[16:19], v5, s[16:19], s12 offen offset:0
  buffer_load_dwordx4 v[20:23], v5, s[16:19], s12 offen offset:64
  buffer_load_dwordx4 v[24:27], v5, s[16:19], s12 offen offset:128
  buffer_load_dwordx4 v[28:31], v5, s[16:19], s12 offen offset:192
  buffer_load_dwordx4 v[32:35], v5, s[16:19], s12 offen offset:256
  s_load_dword s72, s[70:71], 0
  s_mov_b32 s44, s70
  s_mov_b32 s45, s71
  s_mov_b32 s46, 0xe98000
  s_mov_b32 s47, 0x20000
  s_mov_b32 s74, 200000
  s_cmp_eq_u32 s11, 0
  s_cselect_b32 s20, s52, s54
  s_cselect_b32 s21, s53, s55
  s_mov_b32 s22, 0x6400
  s_mov_b32 s23, 0x20000
  s_mov_b32 m0, s15
  s_nop 0
  buffer_load_dwordx4 v2, s[20:23], s14 offen offset:0 lds
  buffer_load_dwordx4 v2, s[20:23], s14 offen offset:1024 lds
  buffer_load_dwordx4 v2, s[20:23], s14 offen offset:2048 lds
  buffer_load_dwordx4 v2, s[20:23], s14 offen offset:3072 lds
  s_add_u32 m0, s15, 4096
  s_nop 0
  buffer_load_dwordx4 v2, s[20:23], s37 offen offset:0 lds
  buffer_load_dwordx4 v2, s[20:23], s37 offen offset:1024 lds
  buffer_load_dwordx4 v2, s[20:23], s37 offen offset:2048 lds
  s_add_u32 s28, s70, 0xc00000
  s_addc_u32 s29, s71, 0
  s_mov_b32 s30, 0x280000
  s_mov_b32 s31, 0x20000
  s_add_u32 s32, s70, 0x20000
  s_addc_u32 s33, s71, 0
  s_mov_b32 s34, 0x30000
  s_mov_b32 s35, 0x20000
  v_mov_b32 v8, 0
  v_mov_b32 v9, 0
  v_mov_b32 v10, 0
  v_mov_b32 v11, 0
  s_mov_b32 s38, 0x3f803f80
  s_lshl_b32 s39, s3, 7
  s_add_u32 s39, s39, 28672
  v_lshl_add_u32 v12, v3, 3, s39
  v_lshlrev_b32 v13, 3, v3
  v_lshrrev_b32 v14, 2, v3
  v_lshl_add_u32 v14, v4, 3, v14
  v_mul_u32_u24 v14, 40, v14
  v_and_b32 v15, 3, v1
  v_lshl_add_u32 v14, v15, 3, v14
  v_add_u32 v14, s15, v14
  s_lshl_b32 s36, s4, 7
  s_add_u32 s36, s36, 4096
  s_lshr_b32 s40, s4, 1
  s_mul_i32 s41, s40, 40960
  s_and_b32 s42, s4, 1
  s_lshl_b32 s43, s42, 8
  s_add_u32 s41, s41, s43
  s_mul_i32 s43, s3, 10240
  s_add_u32 s41, s41, s43
  v_lshlrev_b32 v5, 9, v4
  v_lshl_add_u32 v5, v3, 4, v5
  s_lshl_b32 s39, s3, 11
  s_add_u32 s39, s39, 29184
  v_add_u32 v92, s39, v2
  s_mul_i32 s39, s40, 3072
  s_lshl_b32 s43, s4, 1
  s_add_u32 s43, s43, s11
  s_lshl_b32 s75, s43, 7
  s_add_u32 s75, s75, 15237120
  s_lshl_b32 s43, s43, 2
  s_add_u32 s43, s43, 15204352
  v_lshl_add_u32 v7, s42, 4, v3
  v_and_b32 v15, 1, v4
  v_lshrrev_b32 v6, 1, v4
  v_mov_b32 v95, 0x7fffffff
  s_mov_b64 s[24:25], 0
  s_cmp_lg_u32 s11, 0
  s_cbranch_scc1 parallel_sum__grouped_kv_mqa__swiglu_ffn__prompt_kernel_v9
  v_lshl_add_u32 v93, v6, 5, v7
  v_lshlrev_b32 v93, 4, v93
  v_lshl_add_u32 v93, v15, 3, v93
  v_lshlrev_b32 v94, 3, v7
  v_add_u32 v94, 1024, v94
  v_cmp_ne_u32 vcc, 0, v4
  s_branch parallel_sum__grouped_kv_mqa__swiglu_ffn__prompt_kernel_st10
parallel_sum__grouped_kv_mqa__swiglu_ffn__prompt_kernel_v9:
  s_mul_i32 s26, s42, 768
  s_add_u32 s26, s26, 1536
  s_mov_b32 s24, 0x00100010
  s_mov_b32 s25, 0x00100010
  v_mul_u32_u24 v93, 384, v15
  v_lshl_add_u32 v93, v3, 4, v93
  v_lshl_add_u32 v93, v6, 3, v93
  v_add_u32 v93, s26, v93
  v_add_u32 v94, 256, v93
  v_cmp_lt_u32 vcc, 4, v3
parallel_sum__grouped_kv_mqa__swiglu_ffn__prompt_kernel_st10:
  s_nop 1
  v_cndmask_b32 v94, v94, v95, vcc
  v_mov_b32 v95, 0x3f803f80
  s_waitcnt lgkmcnt(0)
  s_mul_i32 s73, s72, 1664525
  s_add_u32 s73, s73, 1013904223
  s_waitcnt vmcnt(11)
  v_dot2_f32_bf16 v8, v16, s38, v8
  v_dot2_f32_bf16 v10, v16, v16, v10
  v_dot2_f32_bf16 v9, v17, s38, v9
  v_dot2_f32_bf16 v11, v17, v17, v11
  v_dot2_f32_bf16 v8, v18, s38, v8
  v_dot2_f32_bf16 v10, v18, v18, v10
  v_dot2_f32_bf16 v9, v19, s38, v9
  v_dot2_f32_bf16 v11, v19, v19, v11
  s_waitcnt vmcnt(10)
  v_dot2_f32_bf16 v8, v20, s38, v8
  v_dot2_f32_bf16 v10, v20, v20, v10
  v_dot2_f32_bf16 v9, v21, s38, v9
  v_dot2_f32_bf16 v11, v21, v21, v11
  v_dot2_f32_bf16 v8, v22, s38, v8
  v_dot2_f32_bf16 v10, v22, v22, v10
  v_dot2_f32_bf16 v9, v23, s38, v9
  v_dot2_f32_bf16 v11, v23, v23, v11
  s_waitcnt vmcnt(9)
  v_dot2_f32_bf16 v8, v24, s38, v8
  v_dot2_f32_bf16 v10, v24, v24, v10
  v_dot2_f32_bf16 v9, v25, s38, v9
  v_dot2_f32_bf16 v11, v25, v25, v11
  v_dot2_f32_bf16 v8, v26, s38, v8
  v_dot2_f32_bf16 v10, v26, v26, v10
  v_dot2_f32_bf16 v9, v27, s38, v9
  v_dot2_f32_bf16 v11, v27, v27, v11
  s_waitcnt vmcnt(8)
  v_dot2_f32_bf16 v8, v28, s38, v8
  v_dot2_f32_bf16 v10, v28, v28, v10
  v_dot2_f32_bf16 v9, v29, s38, v9
  v_dot2_f32_bf16 v11, v29, v29, v11
  v_dot2_f32_bf16 v8, v30, s38, v8
  v_dot2_f32_bf16 v10, v30, v30, v10
  v_dot2_f32_bf16 v9, v31, s38, v9
  v_dot2_f32_bf16 v11, v31, v31, v11
  s_waitcnt vmcnt(7)
  v_dot2_f32_bf16 v8, v32, s38, v8
  v_dot2_f32_bf16 v10, v32, v32, v10
  v_dot2_f32_bf16 v9, v33, s38, v9
  v_dot2_f32_bf16 v11, v33, v33, v11
  v_dot2_f32_bf16 v8, v34, s38, v8
  v_dot2_f32_bf16 v10, v34, v34, v10
  v_dot2_f32_bf16 v9, v35, s38, v9
  v_dot2_f32_bf16 v11, v35, v35, v11
  s_nop 1
  v_add_f32 v8, v8, v9
  v_add_f32 v9, v10, v11
  v_mov_b32 v10, v8
  v_mov_b32 v11, v9
  s_nop 0
  v_permlane32_swap_b32 v8, v10
  v_permlane32_swap_b32 v9, v11
  v_add_f32 v8, v8, v10
  v_add_f32 v9, v9, v11
  v_mov_b32 v10, v8
  v_mov_b32 v11, v9
  s_nop 0
  v_permlane16_swap_b32 v8, v10
  v_permlane16_swap_b32 v9, v11
  v_add_f32 v8, v8, v10
  v_add_f32 v9, v9, v11
  ds_write_b64 v12, v[8:9]
  v_lshlrev_b32 v96, 16, v16
  v_and_b32 v97, 0xffff0000, v16
  v_lshlrev_b32 v98, 16, v17
  v_and_b32 v99, 0xffff0000, v17
  s_waitcnt lgkmcnt(0)
  s_barrier
  ds_read_b64 v[36:37], v13 offset:28672
  ds_read_b64 v[38:39], v13 offset:28800
  ds_read_b64 v[40:41], v13 offset:28928
  ds_read_b64 v[42:43], v13 offset:29056
  v_lshlrev_b32 v100, 16, v18
  v_and_b32 v101, 0xffff0000, v18
  v_lshlrev_b32 v102, 16, v19
  v_and_b32 v103, 0xffff0000, v19
  v_lshlrev_b32 v104, 16, v20
  v_and_b32 v105, 0xffff0000, v20
  v_lshlrev_b32 v106, 16, v21
  v_and_b32 v107, 0xffff0000, v21
  v_lshlrev_b32 v108, 16, v22
  v_and_b32 v109, 0xffff0000, v22
  v_lshlrev_b32 v110, 16, v23
  v_and_b32 v111, 0xffff0000, v23
  v_lshlrev_b32 v112, 16, v24
  v_and_b32 v113, 0xffff0000, v24
  v_lshlrev_b32 v114, 16, v25
  v_and_b32 v115, 0xffff0000, v25
  v_lshlrev_b32 v116, 16, v26
  v_and_b32 v117, 0xffff0000, v26
  v_lshlrev_b32 v118, 16, v27
  v_and_b32 v119, 0xffff0000, v27
  v_lshlrev_b32 v120, 16, v28
  v_and_b32 v121, 0xffff0000, v28
  v_lshlrev_b32 v122, 16, v29
  v_and_b32 v123, 0xffff0000, v29
  v_lshlrev_b32 v124, 16, v30
  v_and_b32 v125, 0xffff0000, v30
  v_lshlrev_b32 v126, 16, v31
  v_and_b32 v127, 0xffff0000, v31
  v_lshlrev_b32 v128, 16, v32
  v_and_b32 v129, 0xffff0000, v32
  v_lshlrev_b32 v130, 16, v33
  v_and_b32 v131, 0xffff0000, v33
  v_lshlrev_b32 v132, 16, v34
  v_and_b32 v133, 0xffff0000, v34
  v_lshlrev_b32 v134, 16, v35
  v_and_b32 v135, 0xffff0000, v35
  s_waitcnt lgkmcnt(0) vmcnt(0)
  ds_read_b64_tr_b16 v[136:137], v14 offset:0
  ds_read_b64_tr_b16 v[138:139], v14 offset:160
  ds_read_b64_tr_b16 v[140:141], v14 offset:32
  ds_read_b64_tr_b16 v[142:143], v14 offset:192
  ds_read_b64_tr_b16 v[144:145], v14 offset:1280
  ds_read_b64_tr_b16 v[146:147], v14 offset:1440
  ds_read_b64_tr_b16 v[148:149], v14 offset:1312
  ds_read_b64_tr_b16 v[150:151], v14 offset:1472
  ds_read_b64_tr_b16 v[152:153], v14 offset:2560
  ds_read_b64_tr_b16 v[154:155], v14 offset:2720
  ds_read_b64_tr_b16 v[156:157], v14 offset:2592
  ds_read_b64_tr_b16 v[158:159], v14 offset:2752
  ds_read_b64_tr_b16 v[160:161], v14 offset:3840
  ds_read_b64_tr_b16 v[162:163], v14 offset:4000
  ds_read_b64_tr_b16 v[164:165], v14 offset:3872
  ds_read_b64_tr_b16 v[166:167], v14 offset:4032
  ds_read_b64_tr_b16 v[168:169], v14 offset:5120
  ds_read_b64_tr_b16 v[170:171], v14 offset:5280
  ds_read_b64_tr_b16 v[172:173], v14 offset:5152
  ds_read_b64_tr_b16 v[174:175], v14 offset:5312
  v_add_f32 v8, v36, v38
  v_add_f32 v9, v37, v39
  v_add_f32 v10, v40, v42
  v_add_f32 v11, v41, v43
  v_add_f32 v8, v8, v10
  v_add_f32 v9, v9, v11
  v_mul_f32 v8, 0x3acccccd, v8
  v_mul_f32 v9, 0x3acccccd, v9
  v_fma_f32 v9, -v8, v8, v9
  v_max_f32 v9, 0, v9
  v_cvt_pk_bf16_f32 v10, v8, v9
  v_lshlrev_b32 v8, 16, v10
  v_and_b32 v9, 0xffff0000, v10
  v_add_f32 v9, 0x3727c5ac, v9
  v_cvt_pk_bf16_f32 v9, v9, v9
  v_and_b32 v9, 0xffff0000, v9
  v_sqrt_f32 v9, v9
  s_nop 0
  v_cvt_pk_bf16_f32 v6, v8, v9
  v_mov_b32 v7, s73
  v_and_b32 v9, 0xffff0000, v6
  s_lshl_b32 s26, s11, 2
  s_add_u32 s26, s26, s3
  s_cmp_lg_u32 s26, 7
  s_cbranch_scc1 parallel_sum__grouped_kv_mqa__swiglu_ffn__prompt_kernel_nost11
  s_mov_b64 exec, 0xffff
  buffer_store_dwordx2 v[6:7], v13, s[44:47], s36 offen sc1
  s_mov_b64 exec, -1
parallel_sum__grouped_kv_mqa__swiglu_ffn__prompt_kernel_nost11:
  v_rcp_f32 v10, v9
  s_nop 0
  v_mul_f32 v10, 0x3fb8aa3b, v10
  v_mul_f32 v11, v8, v10
  v_fma_f32 v96, v96, v10, -v11
  v_fma_f32 v97, v97, v10, -v11
  v_fma_f32 v98, v98, v10, -v11
  v_fma_f32 v99, v99, v10, -v11
  v_cvt_pk_bf16_f32 v16, v96, v97
  v_fma_f32 v100, v100, v10, -v11
  v_fma_f32 v101, v101, v10, -v11
  v_cvt_pk_bf16_f32 v17, v98, v99
  v_fma_f32 v102, v102, v10, -v11
  v_fma_f32 v103, v103, v10, -v11
  v_cvt_pk_bf16_f32 v18, v100, v101
  v_fma_f32 v104, v104, v10, -v11
  v_fma_f32 v105, v105, v10, -v11
  v_cvt_pk_bf16_f32 v19, v102, v103
  v_fma_f32 v106, v106, v10, -v11
  v_fma_f32 v107, v107, v10, -v11
  v_cvt_pk_bf16_f32 v20, v104, v105
  v_fma_f32 v108, v108, v10, -v11
  v_fma_f32 v109, v109, v10, -v11
  v_cvt_pk_bf16_f32 v21, v106, v107
  v_fma_f32 v110, v110, v10, -v11
  v_fma_f32 v111, v111, v10, -v11
  v_cvt_pk_bf16_f32 v22, v108, v109
  v_fma_f32 v112, v112, v10, -v11
  v_fma_f32 v113, v113, v10, -v11
  v_cvt_pk_bf16_f32 v23, v110, v111
  v_fma_f32 v114, v114, v10, -v11
  v_fma_f32 v115, v115, v10, -v11
  v_cvt_pk_bf16_f32 v24, v112, v113
  v_fma_f32 v116, v116, v10, -v11
  v_fma_f32 v117, v117, v10, -v11
  v_cvt_pk_bf16_f32 v25, v114, v115
  v_fma_f32 v118, v118, v10, -v11
  v_fma_f32 v119, v119, v10, -v11
  v_cvt_pk_bf16_f32 v26, v116, v117
  v_fma_f32 v120, v120, v10, -v11
  v_fma_f32 v121, v121, v10, -v11
  v_cvt_pk_bf16_f32 v27, v118, v119
  v_fma_f32 v122, v122, v10, -v11
  v_fma_f32 v123, v123, v10, -v11
  v_cvt_pk_bf16_f32 v28, v120, v121
  v_fma_f32 v124, v124, v10, -v11
  v_fma_f32 v125, v125, v10, -v11
  v_cvt_pk_bf16_f32 v29, v122, v123
  v_fma_f32 v126, v126, v10, -v11
  v_fma_f32 v127, v127, v10, -v11
  v_cvt_pk_bf16_f32 v30, v124, v125
  v_fma_f32 v128, v128, v10, -v11
  v_fma_f32 v129, v129, v10, -v11
  v_cvt_pk_bf16_f32 v31, v126, v127
  v_fma_f32 v130, v130, v10, -v11
  v_fma_f32 v131, v131, v10, -v11
  v_cvt_pk_bf16_f32 v32, v128, v129
  v_fma_f32 v132, v132, v10, -v11
  v_fma_f32 v133, v133, v10, -v11
  v_cvt_pk_bf16_f32 v33, v130, v131
  v_fma_f32 v134, v134, v10, -v11
  v_fma_f32 v135, v135, v10, -v11
  v_cvt_pk_bf16_f32 v34, v132, v133
  v_cvt_pk_bf16_f32 v35, v134, v135
  s_waitcnt lgkmcnt(0)
  s_cmp_lg_u32 s11, 0
  s_cbranch_scc1 parallel_sum__grouped_kv_mqa__swiglu_ffn__prompt_kernel_mv12
  v_mfma_f32_16x16x32_bf16 v[44:47], v[136:139], v[16:19], 0
  v_mfma_f32_16x16x32_bf16 v[48:51], v[140:143], v[16:19], 0
  v_mfma_f32_16x16x32_bf16 v[44:47], v[144:147], v[20:23], v[44:47]
  v_mfma_f32_16x16x32_bf16 v[48:51], v[148:151], v[20:23], v[48:51]
  v_mfma_f32_16x16x32_bf16 v[44:47], v[152:155], v[24:27], v[44:47]
  v_mfma_f32_16x16x32_bf16 v[48:51], v[156:159], v[24:27], v[48:51]
  v_mfma_f32_16x16x32_bf16 v[44:47], v[160:163], v[28:31], v[44:47]
  v_mfma_f32_16x16x32_bf16 v[48:51], v[164:167], v[28:31], v[48:51]
  v_mfma_f32_16x16x32_bf16 v[44:47], v[168:171], v[32:35], v[44:47]
  v_mfma_f32_16x16x32_bf16 v[48:51], v[172:175], v[32:35], v[48:51]
  s_branch parallel_sum__grouped_kv_mqa__swiglu_ffn__prompt_kernel_md13
parallel_sum__grouped_kv_mqa__swiglu_ffn__prompt_kernel_mv12:
  v_mfma_f32_16x16x32_bf16 v[44:47], v[16:19], v[136:139], 0
  v_mfma_f32_16x16x32_bf16 v[48:51], v[16:19], v[140:143], 0
  v_mfma_f32_16x16x32_bf16 v[44:47], v[20:23], v[144:147], v[44:47]
  v_mfma_f32_16x16x32_bf16 v[48:51], v[20:23], v[148:151], v[48:51]
  v_mfma_f32_16x16x32_bf16 v[44:47], v[24:27], v[152:155], v[44:47]
  v_mfma_f32_16x16x32_bf16 v[48:51], v[24:27], v[156:159], v[48:51]
  v_mfma_f32_16x16x32_bf16 v[44:47], v[28:31], v[160:163], v[44:47]
  v_mfma_f32_16x16x32_bf16 v[48:51], v[28:31], v[164:167], v[48:51]
  v_mfma_f32_16x16x32_bf16 v[44:47], v[32:35], v[168:171], v[44:47]
  v_mfma_f32_16x16x32_bf16 v[48:51], v[32:35], v[172:175], v[48:51]
parallel_sum__grouped_kv_mqa__swiglu_ffn__prompt_kernel_md13:
  s_nop 6
  ds_write_b128 v92, v[44:47] offset:0
  ds_write_b128 v92, v[48:51] offset:1024
  s_waitcnt lgkmcnt(0)
  s_barrier
  s_cmp_lg_u32 s3, 0
  s_cbranch_scc1 parallel_sum__grouped_kv_mqa__swiglu_ffn__prompt_kernel_xst14
  ds_read_b128 v[56:59], v92 offset:2048
  ds_read_b128 v[60:63], v92 offset:4096
  ds_read_b128 v[64:67], v92 offset:6144
  ds_read_b128 v[72:75], v92 offset:3072
  ds_read_b128 v[76:79], v92 offset:5120
  ds_read_b128 v[80:83], v92 offset:7168
  s_waitcnt lgkmcnt(3)
  v_add_f32 v44, v44, v56
  v_add_f32 v60, v60, v64
  v_add_f32 v44, v44, v60
  v_add_f32 v45, v45, v57
  v_add_f32 v61, v61, v65
  v_add_f32 v45, v45, v61
  v_add_f32 v46, v46, v58
  v_add_f32 v62, v62, v66
  v_add_f32 v46, v46, v62
  v_add_f32 v47, v47, v59
  v_add_f32 v63, v63, v67
  v_add_f32 v47, v47, v63
  v_cvt_pk_bf16_f32 v8, v44, v45
  v_cvt_pk_bf16_f32 v9, v46, v47
  buffer_store_dwordx2 v[8:9], v93, s[32:35], s39 offen sc1
  s_waitcnt lgkmcnt(0)
  v_add_f32 v48, v48, v72
  v_add_f32 v76, v76, v80
  v_add_f32 v48, v48, v76
  v_add_f32 v49, v49, v73
  v_add_f32 v77, v77, v81
  v_add_f32 v49, v49, v77
  v_add_f32 v50, v50, v74
  v_add_f32 v78, v78, v82
  v_add_f32 v50, v50, v78
  v_add_f32 v51, v51, v75
  v_add_f32 v79, v79, v83
  v_add_f32 v51, v51, v79
  v_cvt_pk_bf16_f32 v10, v48, v49
  v_cvt_pk_bf16_f32 v11, v50, v51
  v_cndmask_b32 v10, v10, v95, s[24:25]
  v_cndmask_b32 v11, v11, v95, s[24:25]
  buffer_store_dwordx2 v[10:11], v94, s[32:35], s39 offen sc1
parallel_sum__grouped_kv_mqa__swiglu_ffn__prompt_kernel_xst14:
  s_cmp_lg_u32 s11, 0
  s_cbranch_scc1 parallel_sum__grouped_kv_mqa__swiglu_ffn__prompt_kernel_x115
  s_mov_b32 s26, s41
  buffer_store_dwordx4 v[16:19], v5, s[28:31], s26 offen offset:0 sc1
  buffer_store_dwordx4 v[20:23], v5, s[28:31], s26 offen offset:2048 sc1
  s_add_u32 s26, s41, 4096
  buffer_store_dwordx4 v[24:27], v5, s[28:31], s26 offen offset:0 sc1
  s_branch parallel_sum__grouped_kv_mqa__swiglu_ffn__prompt_kernel_x216
parallel_sum__grouped_kv_mqa__swiglu_ffn__prompt_kernel_x115:
  s_add_u32 s26, s41, 4096
  buffer_store_dwordx4 v[28:31], v5, s[28:31], s26 offen offset:2048 sc1
  s_add_u32 s26, s41, 8192
  buffer_store_dwordx4 v[32:35], v5, s[28:31], s26 offen offset:0 sc1
parallel_sum__grouped_kv_mqa__swiglu_ffn__prompt_kernel_x216:
  s_lshr_b32 s7, s5, 1
  s_lshl_b32 s7, s7, 2
  s_lshr_b32 s8, s6, 3
  s_add_u32 s7, s7, s8
  s_and_b32 s9, s5, 1
  s_lshl_b32 s8, s9, 3
  s_and_b32 s10, s6, 7
  s_add_u32 s8, s8, s10
  s_lshl_b32 s11, s7, 1
  s_add_u32 s9, s9, s11
  s_and_b32 s11, s3, 2
  v_add_u32 v232, 0, v1
  v_mul_u32_u24 v233, 5462, v232
  v_lshrrev_b32 v233, 16, v233
  v_mul_u32_u24 v234, 12, v233
  v_sub_u32 v234, v232, v234
  v_xor_b32 v234, s11, v234
  v_mul_u32_u24 v233, 3072, v233
  v_lshl_add_u32 v216, v234, 4, v233
  v_add_u32 v232, 64, v1
  v_mul_u32_u24 v233, 5462, v232
  v_lshrrev_b32 v233, 16, v233
  v_mul_u32_u24 v234, 12, v233
  v_sub_u32 v234, v232, v234
  v_xor_b32 v234, s11, v234
  v_mul_u32_u24 v233, 3072, v233
  v_lshl_add_u32 v217, v234, 4, v233
  v_add_u32 v232, 128, v1
  v_mul_u32_u24 v233, 5462, v232
  v_lshrrev_b32 v233, 16, v233
  v_mul_u32_u24 v234, 12, v233
  v_sub_u32 v234, v232, v234
  v_xor_b32 v234, s11, v234
  v_mul_u32_u24 v233, 3072, v233
  v_lshl_add_u32 v218, v234, 4, v233
  v_lshrrev_b32 v232, 5, v1
  v_bfe_u32 v233, v1, 2, 2
  v_lshl_add_u32 v233, v232, 3, v233
  v_mul_u32_u24 v233, 192, v233
  v_and_b32 v234, 1, v1
  v_lshl_add_u32 v233, v234, 4, v233
  v_bfe_u32 v234, v1, 1, 1
  v_lshl_add_u32 v233, v234, 3, v233
  v_bfe_u32 v234, v1, 4, 1
  v_mul_u32_u24 v235, 6144, v234
  v_add_u32 v233, v233, v235
  s_lshr_b32 s11, s3, 1
  s_mul_i32 s11, s11, 3
  v_xor_b32 v235, s11, v234
  v_lshl_add_u32 v221, v235, 5, v233
  s_add_u32 s11, s11, 1
  v_xor_b32 v235, s11, v234
  v_lshl_add_u32 v222, v235, 5, v233
  s_add_u32 s11, s11, 1
  v_xor_b32 v235, s11, v234
  v_lshl_add_u32 v223, v235, 5, v233
  s_add_u32 s11, s11, 1
  s_and_b32 s11, s3, 1
  s_lshl_b32 s11, s11, 12
  s_add_u32 s11, s11, 12288
  v_add_u32 v224, s11, v2
  v_and_b32 v225, 3, v1
  v_lshlrev_b32 v225, 7, v225
  s_lshr_b32 s38, s3, 1
  s_and_b32 s39, s3, 1
  s_mul_i32 s40, s38, 3
  s_add_u32 s16, s70, 0xc00000
  s_addc_u32 s17, s71, 0
  s_mov_b32 s18, 0x280000
  s_mov_b32 s19, 0x20000
  s_cmp_eq_u32 s38, 0
  s_cselect_b32 s20, s60, s62
  s_cselect_b32 s21, s61, s63
  s_mov_b32 s22, 0x1e0000
  s_mov_b32 s23, 0x20000
  s_mul_i32 s12, s39, 49152
  s_mul_i32 s32, s8, 192
  s_add_u32 s12, s12, s32
  s_lshl_b32 s32, s7, 2
  s_add_u32 s32, s32, s3
  s_mul_i32 s13, s32, 40960
  s_lshl_b32 s42, s32, 9
  s_add_u32 s42, s42, 15237120
  s_mul_i32 s14, s3, 3072
  s_lshl_b32 s15, s3, 11
  s_add_u32 s15, s15, 12288
  s_waitcnt vmcnt(2)
  s_cmp_lg_u32 s3, 0
  s_cbranch_scc1 parallel_sum__grouped_kv_mqa__swiglu_ffn__prompt_kernel_nofl17
  v_mov_b32 v10, s73
  v_mov_b32 v11, 0
  s_mov_b64 exec, 1
  buffer_store_dword v10, v11, s[44:47], s43 offen sc1
  s_mov_b64 exec, -1
parallel_sum__grouped_kv_mqa__swiglu_ffn__prompt_kernel_nofl17:
  s_waitcnt vmcnt(1)
  s_cmp_eq_u32 s3, 0
  s_cbranch_scc1 parallel_sum__grouped_kv_mqa__swiglu_ffn__prompt_kernel_w018
  s_waitcnt vmcnt(0)
parallel_sum__grouped_kv_mqa__swiglu_ffn__prompt_kernel_w018:
  s_barrier
  s_cmp_lg_u32 s3, 0
  s_cbranch_scc1 parallel_sum__grouped_kv_mqa__swiglu_ffn__prompt_kernel_nofl19
  v_mov_b32 v10, s73
  v_mov_b32 v11, 0
  s_mov_b64 exec, 1
  buffer_store_dword v10, v11, s[44:47], s75 offen sc1
  s_mov_b64 exec, -1
parallel_sum__grouped_kv_mqa__swiglu_ffn__prompt_kernel_nofl19:
  s_setprio 0
  s_mov_b32 s11, 0x7ff00000
  s_lshl_b32 s41, s2, 7
  s_add_u32 s41, s41, 15269888
  v_mov_b32 v31, 0
  s_lshr_b32 s4, s2, 1
  s_and_b32 s32, s2, 1
  s_lshl_b32 s32, s32, 7
  s_add_u32 s4, s4, s32
  s_cmp_lt_u32 s4, 136
  s_cbranch_scc1 parallel_sum__grouped_kv_mqa__swiglu_ffn__prompt_kernel_pk6
parallel_sum__grouped_kv_mqa__swiglu_ffn__prompt_kernel_poll20:
  buffer_load_dword v16, v225, s[44:47], s42 offen sc1
  buffer_load_dword v29, v31, s[44:47], s41 offen sc1
parallel_sum__grouped_kv_mqa__swiglu_ffn__prompt_kernel_pchk22:
  s_waitcnt vmcnt(0)
  v_xor_b32 v17, s73, v16
  v_xor_b32 v29, s73, v29
  v_or_b32 v17, v17, v29
  v_cmp_ne_u32 vcc, 0, v17
  s_nop 0
  s_cmp_eq_u64 vcc, 0
  s_cbranch_scc1 parallel_sum__grouped_kv_mqa__swiglu_ffn__prompt_kernel_pdone21
  s_cmp_eq_u32 s74, 0
  s_cbranch_scc1 parallel_sum__grouped_kv_mqa__swiglu_ffn__prompt_kernel_pdone21
  s_sub_u32 s74, s74, 1
  s_sleep 2
  s_branch parallel_sum__grouped_kv_mqa__swiglu_ffn__prompt_kernel_poll20
parallel_sum__grouped_kv_mqa__swiglu_ffn__prompt_kernel_pdone21:
  s_add_u32 m0, s14, 0
  s_nop 0
  buffer_load_dwordx4 v216, s[20:23], s12 offen lds
  s_add_u32 m0, m0, 1024
  s_nop 0
  buffer_load_dwordx4 v217, s[20:23], s12 offen lds
  s_add_u32 m0, m0, 1024
  s_nop 0
  buffer_load_dwordx4 v218, s[20:23], s12 offen lds
  s_add_u32 s12, s12, 98304
  s_add_u32 m0, s15, 0
  s_nop 0
  buffer_load_dwordx4 v2, s[16:19], s13 offen sc1 lds
  buffer_load_dwordx4 v2, s[16:19], s13 offen offset:1024 sc1 lds
  s_add_u32 s13, s13, 2048
  s_add_u32 m0, s14, 20480
  s_nop 0
  buffer_load_dwordx4 v216, s[20:23], s12 offen lds
  s_add_u32 m0, m0, 1024
  s_nop 0
  buffer_load_dwordx4 v217, s[20:23], s12 offen lds
  s_add_u32 m0, m0, 1024
  s_nop 0
  buffer_load_dwordx4 v218, s[20:23], s12 offen lds
  s_add_u32 s12, s12, 98304
  s_add_u32 m0, s15, 20480
  s_nop 0
  buffer_load_dwordx4 v2, s[16:19], s13 offen sc1 lds
  buffer_load_dwordx4 v2, s[16:19], s13 offen offset:1024 sc1 lds
  s_add_u32 s13, s13, 2048
  s_branch parallel_sum__grouped_kv_mqa__swiglu_ffn__prompt_kernel_gu05
parallel_sum__grouped_kv_mqa__swiglu_ffn__prompt_kernel_pk6:
  s_mul_i32 s33, s3, 320
  v_add_u32 v13, 0, v1
  v_add_u32 v13, s33, v13
  v_mul_u32_u24 v19, 52429, v13
  v_lshrrev_b32 v19, 22, v19
  v_mul_u32_u24 v14, 80, v19
  v_sub_u32 v14, v13, v14
  v_lshlrev_b32 v24, 4, v14
  v_add_u32 v13, 64, v1
  v_add_u32 v13, s33, v13
  v_mul_u32_u24 v20, 52429, v13
  v_lshrrev_b32 v20, 22, v20
  v_mul_u32_u24 v14, 80, v20
  v_sub_u32 v14, v13, v14
  v_lshlrev_b32 v25, 4, v14
  v_add_u32 v13, 128, v1
  v_add_u32 v13, s33, v13
  v_mul_u32_u24 v21, 52429, v13
  v_lshrrev_b32 v21, 22, v21
  v_mul_u32_u24 v14, 80, v21
  v_sub_u32 v14, v13, v14
  v_lshlrev_b32 v26, 4, v14
  v_add_u32 v13, 192, v1
  v_add_u32 v13, s33, v13
  v_mul_u32_u24 v22, 52429, v13
  v_lshrrev_b32 v22, 22, v22
  v_mul_u32_u24 v14, 80, v22
  v_sub_u32 v14, v13, v14
  v_lshlrev_b32 v27, 4, v14
  v_add_u32 v13, 256, v1
  v_add_u32 v13, s33, v13
  v_mul_u32_u24 v23, 52429, v13
  v_lshrrev_b32 v23, 22, v23
  v_mul_u32_u24 v14, 80, v23
  v_sub_u32 v14, v13, v14
  v_lshlrev_b32 v28, 4, v14
  v_lshrrev_b32 v8, 5, v1
  v_bfe_u32 v9, v1, 2, 2
  v_lshl_add_u32 v9, v8, 3, v9
  v_mul_u32_u24 v9, 1280, v9
  s_mul_i32 s32, s3, 320
  s_add_u32 s32, s32, 61440
  v_add_u32 v9, s32, v9
  v_and_b32 v16, 1, v1
  v_bfe_u32 v17, v1, 1, 1
  v_bfe_u32 v18, v1, 4, 1
  v_lshl_add_u32 v10, v16, 5, v9
  v_lshl_add_u32 v10, v17, 3, v10
  v_lshl_add_u32 v10, v18, 4, v10
  v_lshl_add_u32 v11, v16, 4, v9
  v_lshl_add_u32 v11, v17, 3, v11
  v_add_u32 v11, 128, v11
  v_lshl_add_u32 v11, v18, 18, v11
  v_and_b32 v12, 15, v1
  v_lshlrev_b32 v12, 4, v12
  v_lshl_add_u32 v12, v8, 8, v12
  v_lshl_add_u32 v12, v18, 30, v12
  s_lshl_b32 s75, s4, 2
  s_add_u32 s75, s75, 2048
  s_mov_b32 s26, 0x1e0000
  s_mul_i32 s32, s4, 241
  s_lshr_b32 s32, s32, 13
  s_mul_i32 s33, s32, 34
  s_sub_u32 s33, s4, s33
  s_mul_i32 s34, s32, 384
  s_lshl_b32 s35, s33, 4
  s_add_u32 s34, s34, s35
  s_sub_u32 s36, s33, 24
  s_sub_u32 s37, s33, 29
  s_cmp_ge_u32 s33, 29
  s_cselect_b32 s36, s37, s36
  s_cselect_b32 s37, 320, 0
  s_mul_i32 s35, s32, 80
  s_add_u32 s35, s35, s37
  s_mul_i32 s37, s36, 20
  s_cmp_eq_u32 s36, 4
  s_cselect_b32 s37, 16, s37
  s_cselect_b32 s43, 16, 0
  s_add_u32 s36, s35, s37
  v_lshrrev_b32 v13, 2, v19
  v_mul_u32_u24 v13, s43, v13
  v_add_u32 v13, v13, v19
  v_mul_u32_u24 v13, 1280, v13
  v_add_u32 v3, v13, v24
  v_lshrrev_b32 v13, 2, v20
  v_mul_u32_u24 v13, s43, v13
  v_add_u32 v13, v13, v20
  v_mul_u32_u24 v13, 1280, v13
  v_add_u32 v4, v13, v25
  v_lshrrev_b32 v13, 2, v21
  v_mul_u32_u24 v13, s43, v13
  v_add_u32 v13, v13, v21
  v_mul_u32_u24 v13, 1280, v13
  v_add_u32 v5, v13, v26
  v_lshrrev_b32 v13, 2, v22
  v_mul_u32_u24 v13, s43, v13
  v_add_u32 v13, v13, v22
  v_mul_u32_u24 v13, 1280, v13
  v_add_u32 v6, v13, v27
  v_lshrrev_b32 v13, 2, v23
  v_mul_u32_u24 v13, s43, v13
  v_add_u32 v13, v13, v23
  v_mul_u32_u24 v13, 1280, v13
  v_add_u32 v7, v13, v28
parallel_sum__grouped_kv_mqa__swiglu_ffn__prompt_kernel_poll23:
  buffer_load_dword v16, v225, s[44:47], s42 offen sc1
  buffer_load_dword v29, v31, s[44:47], s41 offen sc1
parallel_sum__grouped_kv_mqa__swiglu_ffn__prompt_kernel_pchk25:
  s_waitcnt vmcnt(0)
  v_xor_b32 v17, s73, v16
  v_xor_b32 v29, s73, v29
  v_or_b32 v17, v17, v29
  v_cmp_ne_u32 vcc, 0, v17
  s_nop 0
  s_cmp_eq_u64 vcc, 0
  s_cbranch_scc1 parallel_sum__grouped_kv_mqa__swiglu_ffn__prompt_kernel_pdone24
  s_cmp_eq_u32 s74, 0
  s_cbranch_scc1 parallel_sum__grouped_kv_mqa__swiglu_ffn__prompt_kernel_pdone24
  s_sub_u32 s74, s74, 1
  s_sleep 2
  s_branch parallel_sum__grouped_kv_mqa__swiglu_ffn__prompt_kernel_poll23
parallel_sum__grouped_kv_mqa__swiglu_ffn__prompt_kernel_pdone24:
  s_cmp_ge_u32 s33, 24
  s_cselect_b32 s34, s36, s34
  s_cselect_b32 s24, s56, s64
  s_cselect_b32 s25, s57, s65
  s_cselect_b32 s26, 0xc8000, s26
  s_mov_b32 s27, 0x20000
  s_mul_i32 s34, s34, 1280
  s_mul_i32 s35, s3, 5120
  s_add_u32 m0, s35, 61440
  s_nop 0
  buffer_load_dwordx4 v3, s[24:27], s34 offen lds
  s_add_u32 m0, m0, 1024
  s_nop 0
  buffer_load_dwordx4 v4, s[24:27], s34 offen lds
  s_add_u32 m0, m0, 1024
  s_nop 0
  buffer_load_dwordx4 v5, s[24:27], s34 offen lds
  s_add_u32 m0, m0, 1024
  s_nop 0
  buffer_load_dwordx4 v6, s[24:27], s34 offen lds
  s_add_u32 m0, m0, 1024
  s_nop 0
  buffer_load_dwordx4 v7, s[24:27], s34 offen lds
  s_add_u32 m0, s14, 0
  s_nop 0
  buffer_load_dwordx4 v216, s[20:23], s12 offen lds
  s_add_u32 m0, m0, 1024
  s_nop 0
  buffer_load_dwordx4 v217, s[20:23], s12 offen lds
  s_add_u32 m0, m0, 1024
  s_nop 0
  buffer_load_dwordx4 v218, s[20:23], s12 offen lds
  s_add_u32 s12, s12, 98304
  s_add_u32 m0, s15, 0
  s_nop 0
  buffer_load_dwordx4 v2, s[16:19], s13 offen sc1 lds
  buffer_load_dwordx4 v2, s[16:19], s13 offen offset:1024 sc1 lds
  s_add_u32 s13, s13, 2048
  s_add_u32 m0, s14, 20480
  s_nop 0
  buffer_load_dwordx4 v216, s[20:23], s12 offen lds
  s_add_u32 m0, m0, 1024
  s_nop 0
  buffer_load_dwordx4 v217, s[20:23], s12 offen lds
  s_add_u32 m0, m0, 1024
  s_nop 0
  buffer_load_dwordx4 v218, s[20:23], s12 offen lds
  s_add_u32 s12, s12, 98304
  s_add_u32 m0, s15, 20480
  s_nop 0
  buffer_load_dwordx4 v2, s[16:19], s13 offen sc1 lds
  buffer_load_dwordx4 v2, s[16:19], s13 offen offset:1024 sc1 lds
  s_add_u32 s13, s13, 2048
  s_waitcnt vmcnt(10)
  s_barrier
  ds_read_b64_tr_b16 v[128:129], v10 offset:0
  ds_read_b64_tr_b16 v[130:131], v10 offset:5120
  ds_read_b64_tr_b16 v[132:133], v10 offset:64
  ds_read_b64_tr_b16 v[134:135], v10 offset:5184
  ds_read_b64_tr_b16 v[136:137], v11 offset:0
  ds_read_b64_tr_b16 v[138:139], v11 offset:5120
  ds_read_b64_tr_b16 v[140:141], v10 offset:160
  ds_read_b64_tr_b16 v[142:143], v10 offset:5280
  ds_read_b64_tr_b16 v[144:145], v10 offset:224
  ds_read_b64_tr_b16 v[146:147], v10 offset:5344
  ds_read_b64_tr_b16 v[148:149], v11 offset:160
  ds_read_b64_tr_b16 v[150:151], v11 offset:5280
  s_mul_i32 s5, s3, 696320
  s_mul_i32 s6, s4, 2560
  s_add_u32 s5, s5, s6
  s_add_u32 s6, s5, 348160
  s_waitcnt lgkmcnt(0)
parallel_sum__grouped_kv_mqa__swiglu_ffn__prompt_kernel_gu05:
  s_add_u32 s28, s70, 0x300000
  s_addc_u32 s29, s71, 0
  s_mov_b32 s30, 0x880000
  s_mov_b32 s31, 0x20000
  s_mov_b32 s42, 0
  v_min_u32 v4, 33, v1
  v_lshlrev_b32 v4, 4, v4
  s_waitcnt vmcnt(5)
  s_barrier
  s_setprio 0
  ds_read_b128 v[188:191], v224 offset:0
  ds_read_b64_tr_b16 v[176:177], v221 offset:0
  ds_read_b64_tr_b16 v[178:179], v221 offset:768
  ds_read_b128 v[192:195], v224 offset:2048
  ds_read_b64_tr_b16 v[180:181], v222 offset:0
  ds_read_b64_tr_b16 v[182:183], v222 offset:768
  ds_read_b64_tr_b16 v[184:185], v223 offset:0
  ds_read_b64_tr_b16 v[186:187], v223 offset:768
  s_add_u32 s24, s70, 0x50000
  s_addc_u32 s25, s71, 0
  s_mov_b32 s26, 0x2a8000
  s_mov_b32 s27, 0x20000
  s_mul_i32 s11, s10, 348160
  s_mul_i32 s43, s3, 5120
  s_add_u32 s11, s11, s43
  s_mov_b32 s35, 0x7ff00000
  s_add_u32 m0, s14, 40960
  s_nop 0
  buffer_load_dwordx4 v216, s[20:23], s12 offen lds
  s_add_u32 m0, m0, 1024
  s_nop 0
  buffer_load_dwordx4 v217, s[20:23], s12 offen lds
  s_add_u32 m0, m0, 1024
  s_nop 0
  buffer_load_dwordx4 v218, s[20:23], s12 offen lds
  s_add_u32 s12, s12, 98304
  s_waitcnt lgkmcnt(0)
  v_mfma_f32_32x32x16_bf16 v[32:47], v[176:179], v[188:191], 0
  ds_read_b128 v[208:211], v224 offset:1024
  ds_read_b64_tr_b16 v[196:197], v221 offset:3072
  s_add_u32 m0, s15, 40960
  s_nop 0
  buffer_load_dwordx4 v2, s[16:19], s13 offen sc1 lds
  v_mfma_f32_32x32x16_bf16 v[48:63], v[176:179], v[192:195], 0
  ds_read_b64_tr_b16 v[198:199], v221 offset:3840
  ds_read_b128 v[212:215], v224 offset:3072
  buffer_load_dwordx4 v2, s[16:19], s13 offen offset:1024 sc1 lds
  s_add_u32 s13, s13, 2048
  s_add_u32 m0, s14, 61440
  v_mfma_f32_32x32x16_bf16 v[64:79], v[180:183], v[188:191], 0
  ds_read_b64_tr_b16 v[200:201], v222 offset:3072
  ds_read_b64_tr_b16 v[202:203], v222 offset:3840
  buffer_load_dwordx4 v216, s[20:23], s12 offen lds
  s_add_u32 m0, m0, 1024
  s_nop 0
  buffer_load_dwordx4 v217, s[20:23], s12 offen lds
  s_add_u32 m0, m0, 1024
  v_mfma_f32_32x32x16_bf16 v[80:95], v[180:183], v[192:195], 0
  ds_read_b64_tr_b16 v[204:205], v223 offset:3072
  ds_read_b64_tr_b16 v[206:207], v223 offset:3840
  buffer_load_dwordx4 v218, s[20:23], s12 offen lds
  s_add_u32 s12, s12, 98304
  s_add_u32 m0, s15, 61440
  v_mfma_f32_32x32x16_bf16 v[96:111], v[184:187], v[188:191], 0
  buffer_load_dwordx4 v2, s[16:19], s13 offen sc1 lds
  buffer_load_dwordx4 v2, s[16:19], s13 offen offset:1024 sc1 lds
  s_add_u32 s13, s13, 2048
  v_mfma_f32_32x32x16_bf16 v[112:127], v[184:187], v[192:195], 0
  s_branch parallel_sum__grouped_kv_mqa__swiglu_ffn__prompt_kernel_gum27
.p2align 6
parallel_sum__grouped_kv_mqa__swiglu_ffn__prompt_kernel_gu26:
  s_waitcnt lgkmcnt(0)
  v_mfma_f32_32x32x16_bf16 v[32:47], v[176:179], v[188:191], v[32:47]
  ds_read_b128 v[208:211], v224 offset:1024
  ds_read_b64_tr_b16 v[196:197], v221 offset:3072
  v_mfma_f32_32x32x16_bf16 v[48:63], v[176:179], v[192:195], v[48:63]
  ds_read_b64_tr_b16 v[198:199], v221 offset:3840
  ds_read_b128 v[212:215], v224 offset:3072
  v_mfma_f32_32x32x16_bf16 v[64:79], v[180:183], v[188:191], v[64:79]
  ds_read_b64_tr_b16 v[200:201], v222 offset:3072
  ds_read_b64_tr_b16 v[202:203], v222 offset:3840
  v_mfma_f32_32x32x16_bf16 v[80:95], v[180:183], v[192:195], v[80:95]
  ds_read_b64_tr_b16 v[204:205], v223 offset:3072
  ds_read_b64_tr_b16 v[206:207], v223 offset:3840
  v_mfma_f32_32x32x16_bf16 v[96:111], v[184:187], v[188:191], v[96:111]
  v_mfma_f32_32x32x16_bf16 v[112:127], v[184:187], v[192:195], v[112:127]
  s_cmp_ge_u32 s4, 136
  s_cbranch_scc1 parallel_sum__grouped_kv_mqa__swiglu_ffn__prompt_kernel_nps28
  s_cmp_lg_u32 s42, 1
  s_cbranch_scc1 parallel_sum__grouped_kv_mqa__swiglu_ffn__prompt_kernel_nps28
  buffer_store_dwordx4 v[128:131], v2, s[24:27], s5 offen offset:0 sc1
  buffer_store_dwordx4 v[132:135], v2, s[24:27], s5 offen offset:1024 sc1
  buffer_store_dwordx4 v[136:139], v12, s[24:27], s5 offen offset:2048 sc1
  buffer_store_dwordx4 v[140:143], v2, s[24:27], s6 offen offset:0 sc1
  buffer_store_dwordx4 v[144:147], v2, s[24:27], s6 offen offset:1024 sc1
  buffer_store_dwordx4 v[148:151], v12, s[24:27], s6 offen offset:2048 sc1
parallel_sum__grouped_kv_mqa__swiglu_ffn__prompt_kernel_nps28:
parallel_sum__grouped_kv_mqa__swiglu_ffn__prompt_kernel_gum27:
  s_waitcnt vmcnt(10) lgkmcnt(0)
  s_barrier
  v_mfma_f32_32x32x16_bf16 v[32:47], v[196:199], v[208:211], v[32:47]
  ds_read_b128 v[188:191], v224 offset:20480
  ds_read_b64_tr_b16 v[176:177], v221 offset:20480
  s_add_u32 m0, s14, 0
  v_mfma_f32_32x32x16_bf16 v[48:63], v[196:199], v[212:215], v[48:63]
  ds_read_b64_tr_b16 v[178:179], v221 offset:21248
  ds_read_b128 v[192:195], v224 offset:22528
  buffer_load_dwordx4 v216, s[20:23], s12 offen lds
  s_add_u32 m0, m0, 1024
  v_mfma_f32_32x32x16_bf16 v[64:79], v[200:203], v[208:211], v[64:79]
  ds_read_b64_tr_b16 v[180:181], v222 offset:20480
  ds_read_b64_tr_b16 v[182:183], v222 offset:21248
  buffer_load_dwordx4 v217, s[20:23], s12 offen lds
  s_add_u32 m0, m0, 1024
  v_mfma_f32_32x32x16_bf16 v[80:95], v[200:203], v[212:215], v[80:95]
  ds_read_b64_tr_b16 v[184:185], v223 offset:20480
  ds_read_b64_tr_b16 v[186:187], v223 offset:21248
  buffer_load_dwordx4 v218, s[20:23], s12 offen lds
  s_add_u32 s12, s12, 98304
  s_add_u32 m0, s15, 0
  v_mfma_f32_32x32x16_bf16 v[96:111], v[204:207], v[208:211], v[96:111]
  buffer_load_dwordx4 v2, s[16:19], s13 offen sc1 lds
  v_mfma_f32_32x32x16_bf16 v[112:127], v[204:207], v[212:215], v[112:127]
  buffer_load_dwordx4 v2, s[16:19], s13 offen offset:1024 sc1 lds
  s_add_u32 s13, s13, 2048
  s_waitcnt lgkmcnt(0)
  v_mfma_f32_32x32x16_bf16 v[32:47], v[176:179], v[188:191], v[32:47]
  ds_read_b128 v[208:211], v224 offset:21504
  ds_read_b64_tr_b16 v[196:197], v221 offset:23552
  v_mfma_f32_32x32x16_bf16 v[48:63], v[176:179], v[192:195], v[48:63]
  ds_read_b64_tr_b16 v[198:199], v221 offset:24320
  ds_read_b128 v[212:215], v224 offset:23552
  v_mfma_f32_32x32x16_bf16 v[64:79], v[180:183], v[188:191], v[64:79]
  ds_read_b64_tr_b16 v[200:201], v222 offset:23552
  ds_read_b64_tr_b16 v[202:203], v222 offset:24320
  v_mfma_f32_32x32x16_bf16 v[80:95], v[180:183], v[192:195], v[80:95]
  ds_read_b64_tr_b16 v[204:205], v223 offset:23552
  ds_read_b64_tr_b16 v[206:207], v223 offset:24320
  v_mfma_f32_32x32x16_bf16 v[96:111], v[184:187], v[188:191], v[96:111]
  s_cmp_eq_u32 s42, 3
  s_cselect_b32 s36, 2048, s35
  buffer_load_dwordx4 v[16:19], v4, s[44:47], s36 offen sc1
  v_mfma_f32_32x32x16_bf16 v[112:127], v[184:187], v[192:195], v[112:127]
  s_cmp_ge_u32 s4, 136
  s_cbranch_scc1 parallel_sum__grouped_kv_mqa__swiglu_ffn__prompt_kernel_npf29
  s_cmp_lg_u32 s42, 2
  s_cbranch_scc1 parallel_sum__grouped_kv_mqa__swiglu_ffn__prompt_kernel_npf29
  s_cmp_lg_u32 s3, 0
  s_cbranch_scc1 parallel_sum__grouped_kv_mqa__swiglu_ffn__prompt_kernel_nofl30
  v_mov_b32 v10, s73
  v_mov_b32 v11, 0
  s_mov_b64 exec, 1
  buffer_store_dword v10, v11, s[44:47], s75 offen sc1
  s_mov_b64 exec, -1
parallel_sum__grouped_kv_mqa__swiglu_ffn__prompt_kernel_nofl30:
parallel_sum__grouped_kv_mqa__swiglu_ffn__prompt_kernel_npf29:
  s_waitcnt vmcnt(10) lgkmcnt(0)
  s_barrier
  v_mfma_f32_32x32x16_bf16 v[32:47], v[196:199], v[208:211], v[32:47]
  ds_read_b128 v[188:191], v224 offset:40960
  ds_read_b64_tr_b16 v[176:177], v221 offset:40960
  s_add_u32 m0, s14, 20480
  v_mfma_f32_32x32x16_bf16 v[48:63], v[196:199], v[212:215], v[48:63]
  ds_read_b64_tr_b16 v[178:179], v221 offset:41728
  ds_read_b128 v[192:195], v224 offset:43008
  buffer_load_dwordx4 v216, s[20:23], s12 offen lds
  s_add_u32 m0, m0, 1024
  v_mfma_f32_32x32x16_bf16 v[64:79], v[200:203], v[208:211], v[64:79]
  ds_read_b64_tr_b16 v[180:181], v222 offset:40960
  ds_read_b64_tr_b16 v[182:183], v222 offset:41728
  buffer_load_dwordx4 v217, s[20:23], s12 offen lds
  s_add_u32 m0, m0, 1024
  v_mfma_f32_32x32x16_bf16 v[80:95], v[200:203], v[212:215], v[80:95]
  ds_read_b64_tr_b16 v[184:185], v223 offset:40960
  ds_read_b64_tr_b16 v[186:187], v223 offset:41728
  buffer_load_dwordx4 v218, s[20:23], s12 offen lds
  s_add_u32 s12, s12, 98304
  s_add_u32 m0, s15, 20480
  v_mfma_f32_32x32x16_bf16 v[96:111], v[204:207], v[208:211], v[96:111]
  buffer_load_dwordx4 v2, s[16:19], s13 offen sc1 lds
  v_mfma_f32_32x32x16_bf16 v[112:127], v[204:207], v[212:215], v[112:127]
  buffer_load_dwordx4 v2, s[16:19], s13 offen offset:1024 sc1 lds
  s_add_u32 s13, s13, 2048
  s_waitcnt lgkmcnt(0)
  v_mfma_f32_32x32x16_bf16 v[32:47], v[176:179], v[188:191], v[32:47]
  ds_read_b128 v[208:211], v224 offset:41984
  ds_read_b64_tr_b16 v[196:197], v221 offset:44032
  v_mfma_f32_32x32x16_bf16 v[48:63], v[176:179], v[192:195], v[48:63]
  ds_read_b64_tr_b16 v[198:199], v221 offset:44800
  ds_read_b128 v[212:215], v224 offset:44032
  v_mfma_f32_32x32x16_bf16 v[64:79], v[180:183], v[188:191], v[64:79]
  ds_read_b64_tr_b16 v[200:201], v222 offset:44032
  ds_read_b64_tr_b16 v[202:203], v222 offset:44800
  v_mfma_f32_32x32x16_bf16 v[80:95], v[180:183], v[192:195], v[80:95]
  ds_read_b64_tr_b16 v[204:205], v223 offset:44032
  ds_read_b64_tr_b16 v[206:207], v223 offset:44800
  v_mfma_f32_32x32x16_bf16 v[96:111], v[184:187], v[188:191], v[96:111]
  v_mfma_f32_32x32x16_bf16 v[112:127], v[184:187], v[192:195], v[112:127]
  s_waitcnt vmcnt(10) lgkmcnt(0)
  s_barrier
  v_mfma_f32_32x32x16_bf16 v[32:47], v[196:199], v[208:211], v[32:47]
  ds_read_b128 v[188:191], v224 offset:61440
  ds_read_b64_tr_b16 v[176:177], v221 offset:61440
  s_add_u32 m0, s14, 40960
  v_mfma_f32_32x32x16_bf16 v[48:63], v[196:199], v[212:215], v[48:63]
  ds_read_b64_tr_b16 v[178:179], v221 offset:62208
  ds_read_b128 v[192:195], v224 offset:63488
  buffer_load_dwordx4 v216, s[20:23], s12 offen lds
  s_add_u32 m0, m0, 1024
  v_mfma_f32_32x32x16_bf16 v[64:79], v[200:203], v[208:211], v[64:79]
  ds_read_b64_tr_b16 v[180:181], v222 offset:61440
  ds_read_b64_tr_b16 v[182:183], v222 offset:62208
  buffer_load_dwordx4 v217, s[20:23], s12 offen lds
  s_add_u32 m0, m0, 1024
  v_mfma_f32_32x32x16_bf16 v[80:95], v[200:203], v[212:215], v[80:95]
  ds_read_b64_tr_b16 v[184:185], v223 offset:61440
  ds_read_b64_tr_b16 v[186:187], v223 offset:62208
  buffer_load_dwordx4 v218, s[20:23], s12 offen lds
  s_add_u32 s12, s12, 98304
  s_add_u32 m0, s15, 40960
  v_mfma_f32_32x32x16_bf16 v[96:111], v[204:207], v[208:211], v[96:111]
  buffer_load_dwordx4 v2, s[16:19], s13 offen sc1 lds
  v_mfma_f32_32x32x16_bf16 v[112:127], v[204:207], v[212:215], v[112:127]
  buffer_load_dwordx4 v2, s[16:19], s13 offen offset:1024 sc1 lds
  s_add_u32 s13, s13, 2048
  s_waitcnt lgkmcnt(0)
  v_mfma_f32_32x32x16_bf16 v[32:47], v[176:179], v[188:191], v[32:47]
  ds_read_b128 v[208:211], v224 offset:62464
  ds_read_b64_tr_b16 v[196:197], v221 offset:64512
  v_mfma_f32_32x32x16_bf16 v[48:63], v[176:179], v[192:195], v[48:63]
  ds_read_b64_tr_b16 v[198:199], v221 offset:65280
  ds_read_b128 v[212:215], v224 offset:64512
  v_mfma_f32_32x32x16_bf16 v[64:79], v[180:183], v[188:191], v[64:79]
  ds_read_b64_tr_b16 v[200:201], v222 offset:64512
  ds_read_b64_tr_b16 v[202:203], v222 offset:65280
  v_mfma_f32_32x32x16_bf16 v[80:95], v[180:183], v[192:195], v[80:95]
  ds_read_b64_tr_b16 v[204:205], v223 offset:64512
  ds_read_b64_tr_b16 v[206:207], v223 offset:65280
  v_mfma_f32_32x32x16_bf16 v[96:111], v[184:187], v[188:191], v[96:111]
  v_mfma_f32_32x32x16_bf16 v[112:127], v[184:187], v[192:195], v[112:127]
  s_waitcnt vmcnt(10) lgkmcnt(0)
  s_barrier
  v_mfma_f32_32x32x16_bf16 v[32:47], v[196:199], v[208:211], v[32:47]
  ds_read_b128 v[188:191], v224 offset:0
  ds_read_b64_tr_b16 v[176:177], v221 offset:0
  s_add_u32 m0, s14, 61440
  v_mfma_f32_32x32x16_bf16 v[48:63], v[196:199], v[212:215], v[48:63]
  ds_read_b64_tr_b16 v[178:179], v221 offset:768
  ds_read_b128 v[192:195], v224 offset:2048
  buffer_load_dwordx4 v216, s[20:23], s12 offen lds
  s_add_u32 m0, m0, 1024
  v_mfma_f32_32x32x16_bf16 v[64:79], v[200:203], v[208:211], v[64:79]
  ds_read_b64_tr_b16 v[180:181], v222 offset:0
  ds_read_b64_tr_b16 v[182:183], v222 offset:768
  buffer_load_dwordx4 v217, s[20:23], s12 offen lds
  s_add_u32 m0, m0, 1024
  v_mfma_f32_32x32x16_bf16 v[80:95], v[200:203], v[212:215], v[80:95]
  ds_read_b64_tr_b16 v[184:185], v223 offset:0
  ds_read_b64_tr_b16 v[186:187], v223 offset:768
  buffer_load_dwordx4 v218, s[20:23], s12 offen lds
  s_add_u32 s12, s12, 98304
  s_add_u32 m0, s15, 61440
  v_mfma_f32_32x32x16_bf16 v[96:111], v[204:207], v[208:211], v[96:111]
  buffer_load_dwordx4 v2, s[16:19], s13 offen sc1 lds
  v_mfma_f32_32x32x16_bf16 v[112:127], v[204:207], v[212:215], v[112:127]
  buffer_load_dwordx4 v2, s[16:19], s13 offen offset:1024 sc1 lds
  s_add_u32 s13, s13, 2048
  s_add_u32 s42, s42, 1
  s_cmp_lt_u32 s42, 4
  s_cbranch_scc1 parallel_sum__grouped_kv_mqa__swiglu_ffn__prompt_kernel_gu26
  s_setprio 2
  v_xor_b32 v20, s73, v16
  v_xor_b32 v17, s73, v17
  v_or_b32 v20, v20, v17
  v_xor_b32 v18, s73, v18
  v_or_b32 v20, v20, v18
  v_xor_b32 v19, s73, v19
  v_or_b32 v20, v20, v19
  v_cmp_ne_u32 vcc, 0, v20
  s_nop 0
  s_cmp_eq_u64 vcc, 0
  s_cbranch_scc1 parallel_sum__grouped_kv_mqa__swiglu_ffn__prompt_kernel_pkok31
parallel_sum__grouped_kv_mqa__swiglu_ffn__prompt_kernel_poll32:
  buffer_load_dwordx4 v[16:19], v4, s[44:47], s36 offen sc1
parallel_sum__grouped_kv_mqa__swiglu_ffn__prompt_kernel_pchk34:
  s_waitcnt vmcnt(0)
  v_xor_b32 v20, s73, v16
  v_xor_b32 v17, s73, v17
  v_or_b32 v20, v20, v17
  v_xor_b32 v18, s73, v18
  v_or_b32 v20, v20, v18
  v_xor_b32 v19, s73, v19
  v_or_b32 v20, v20, v19
  v_cmp_ne_u32 vcc, 0, v20
  s_nop 0
  s_cmp_eq_u64 vcc, 0
  s_cbranch_scc1 parallel_sum__grouped_kv_mqa__swiglu_ffn__prompt_kernel_pdone33
  s_cmp_eq_u32 s74, 0
  s_cbranch_scc1 parallel_sum__grouped_kv_mqa__swiglu_ffn__prompt_kernel_pdone33
  s_sub_u32 s74, s74, 1
  s_sleep 1
  s_branch parallel_sum__grouped_kv_mqa__swiglu_ffn__prompt_kernel_poll32
parallel_sum__grouped_kv_mqa__swiglu_ffn__prompt_kernel_pdone33:
parallel_sum__grouped_kv_mqa__swiglu_ffn__prompt_kernel_pkok31:
  s_setprio 0
  s_waitcnt lgkmcnt(0)
  v_mfma_f32_32x32x16_bf16 v[32:47], v[176:179], v[188:191], v[32:47]
  ds_read_b128 v[208:211], v224 offset:1024
  ds_read_b64_tr_b16 v[196:197], v221 offset:3072
  v_mfma_f32_32x32x16_bf16 v[48:63], v[176:179], v[192:195], v[48:63]
  ds_read_b64_tr_b16 v[198:199], v221 offset:3840
  ds_read_b128 v[212:215], v224 offset:3072
  v_mfma_f32_32x32x16_bf16 v[64:79], v[180:183], v[188:191], v[64:79]
  ds_read_b64_tr_b16 v[200:201], v222 offset:3072
  ds_read_b64_tr_b16 v[202:203], v222 offset:3840
  v_mfma_f32_32x32x16_bf16 v[80:95], v[180:183], v[192:195], v[80:95]
  ds_read_b64_tr_b16 v[204:205], v223 offset:3072
  ds_read_b64_tr_b16 v[206:207], v223 offset:3840
  v_mfma_f32_32x32x16_bf16 v[96:111], v[184:187], v[188:191], v[96:111]
  v_mfma_f32_32x32x16_bf16 v[112:127], v[184:187], v[192:195], v[112:127]
  s_waitcnt vmcnt(10) lgkmcnt(0)
  s_barrier
  v_mfma_f32_32x32x16_bf16 v[32:47], v[196:199], v[208:211], v[32:47]
  ds_read_b128 v[188:191], v224 offset:20480
  ds_read_b64_tr_b16 v[176:177], v221 offset:20480
  s_add_u32 m0, s43, 0
  s_add_u32 s33, s11, 4096
  v_mfma_f32_32x32x16_bf16 v[48:63], v[196:199], v[212:215], v[48:63]
  ds_read_b64_tr_b16 v[178:179], v221 offset:21248
  ds_read_b128 v[192:195], v224 offset:22528
  buffer_load_dwordx4 v2, s[24:27], s11 offen offset:0 sc1 lds
  v_mfma_f32_32x32x16_bf16 v[64:79], v[200:203], v[208:211], v[64:79]
  ds_read_b64_tr_b16 v[180:181], v222 offset:20480
  ds_read_b64_tr_b16 v[182:183], v222 offset:21248
  buffer_load_dwordx4 v2, s[24:27], s11 offen offset:1024 sc1 lds
  v_mfma_f32_32x32x16_bf16 v[80:95], v[200:203], v[212:215], v[80:95]
  ds_read_b64_tr_b16 v[184:185], v223 offset:20480
  ds_read_b64_tr_b16 v[186:187], v223 offset:21248
  buffer_load_dwordx4 v2, s[24:27], s11 offen offset:2048 sc1 lds
  v_mfma_f32_32x32x16_bf16 v[96:111], v[204:207], v[208:211], v[96:111]
  buffer_load_dwordx4 v2, s[24:27], s11 offen offset:3072 sc1 lds
  s_add_u32 m0, m0, 4096
  v_mfma_f32_32x32x16_bf16 v[112:127], v[204:207], v[212:215], v[112:127]
  buffer_load_dwordx4 v2, s[24:27], s33 offen sc1 lds
  s_add_u32 s11, s11, 87040
  s_waitcnt lgkmcnt(0)
  v_mfma_f32_32x32x16_bf16 v[32:47], v[176:179], v[188:191], v[32:47]
  ds_read_b128 v[208:211], v224 offset:21504
  ds_read_b64_tr_b16 v[196:197], v221 offset:23552
  v_mfma_f32_32x32x16_bf16 v[48:63], v[176:179], v[192:195], v[48:63]
  ds_read_b64_tr_b16 v[198:199], v221 offset:24320
  ds_read_b128 v[212:215], v224 offset:23552
  v_mfma_f32_32x32x16_bf16 v[64:79], v[180:183], v[188:191], v[64:79]
  ds_read_b64_tr_b16 v[200:201], v222 offset:23552
  ds_read_b64_tr_b16 v[202:203], v222 offset:24320
  v_mfma_f32_32x32x16_bf16 v[80:95], v[180:183], v[192:195], v[80:95]
  ds_read_b64_tr_b16 v[204:205], v223 offset:23552
  ds_read_b64_tr_b16 v[206:207], v223 offset:24320
  v_mfma_f32_32x32x16_bf16 v[96:111], v[184:187], v[188:191], v[96:111]
  v_mfma_f32_32x32x16_bf16 v[112:127], v[184:187], v[192:195], v[112:127]
  s_waitcnt vmcnt(10) lgkmcnt(0)
  s_barrier
  v_mfma_f32_32x32x16_bf16 v[32:47], v[196:199], v[208:211], v[32:47]
  ds_read_b128 v[188:191], v224 offset:40960
  ds_read_b64_tr_b16 v[176:177], v221 offset:40960
  s_add_u32 m0, s43, 20480
  s_add_u32 s33, s11, 4096
  v_mfma_f32_32x32x16_bf16 v[48:63], v[196:199], v[212:215], v[48:63]
  ds_read_b64_tr_b16 v[178:179], v221 offset:41728
  ds_read_b128 v[192:195], v224 offset:43008
  buffer_load_dwordx4 v2, s[24:27], s11 offen offset:0 sc1 lds
  v_mfma_f32_32x32x16_bf16 v[64:79], v[200:203], v[208:211], v[64:79]
  ds_read_b64_tr_b16 v[180:181], v222 offset:40960
  ds_read_b64_tr_b16 v[182:183], v222 offset:41728
  buffer_load_dwordx4 v2, s[24:27], s11 offen offset:1024 sc1 lds
  v_mfma_f32_32x32x16_bf16 v[80:95], v[200:203], v[212:215], v[80:95]
  ds_read_b64_tr_b16 v[184:185], v223 offset:40960
  ds_read_b64_tr_b16 v[186:187], v223 offset:41728
  buffer_load_dwordx4 v2, s[24:27], s11 offen offset:2048 sc1 lds
  v_mfma_f32_32x32x16_bf16 v[96:111], v[204:207], v[208:211], v[96:111]
  buffer_load_dwordx4 v2, s[24:27], s11 offen offset:3072 sc1 lds
  s_add_u32 m0, m0, 4096
  v_mfma_f32_32x32x16_bf16 v[112:127], v[204:207], v[212:215], v[112:127]
  buffer_load_dwordx4 v2, s[24:27], s33 offen sc1 lds
  s_add_u32 s11, s11, 87040
  s_waitcnt lgkmcnt(0)
  v_mfma_f32_32x32x16_bf16 v[32:47], v[176:179], v[188:191], v[32:47]
  ds_read_b128 v[208:211], v224 offset:41984
  ds_read_b64_tr_b16 v[196:197], v221 offset:44032
  v_mfma_f32_32x32x16_bf16 v[48:63], v[176:179], v[192:195], v[48:63]
  ds_read_b64_tr_b16 v[198:199], v221 offset:44800
  ds_read_b128 v[212:215], v224 offset:44032
  v_mfma_f32_32x32x16_bf16 v[64:79], v[180:183], v[188:191], v[64:79]
  ds_read_b64_tr_b16 v[200:201], v222 offset:44032
  ds_read_b64_tr_b16 v[202:203], v222 offset:44800
  v_mfma_f32_32x32x16_bf16 v[80:95], v[180:183], v[192:195], v[80:95]
  ds_read_b64_tr_b16 v[204:205], v223 offset:44032
  ds_read_b64_tr_b16 v[206:207], v223 offset:44800
  v_mfma_f32_32x32x16_bf16 v[96:111], v[184:187], v[188:191], v[96:111]
  v_mfma_f32_32x32x16_bf16 v[112:127], v[184:187], v[192:195], v[112:127]
  s_waitcnt vmcnt(10) lgkmcnt(0)
  s_barrier
  v_mfma_f32_32x32x16_bf16 v[32:47], v[196:199], v[208:211], v[32:47]
  ds_read_b128 v[188:191], v224 offset:61440
  ds_read_b64_tr_b16 v[176:177], v221 offset:61440
  s_add_u32 m0, s43, 40960
  s_add_u32 s33, s11, 4096
  v_mfma_f32_32x32x16_bf16 v[48:63], v[196:199], v[212:215], v[48:63]
  ds_read_b64_tr_b16 v[178:179], v221 offset:62208
  ds_read_b128 v[192:195], v224 offset:63488
  buffer_load_dwordx4 v2, s[24:27], s11 offen offset:0 sc1 lds
  v_mfma_f32_32x32x16_bf16 v[64:79], v[200:203], v[208:211], v[64:79]
  ds_read_b64_tr_b16 v[180:181], v222 offset:61440
  ds_read_b64_tr_b16 v[182:183], v222 offset:62208
  buffer_load_dwordx4 v2, s[24:27], s11 offen offset:1024 sc1 lds
  v_mfma_f32_32x32x16_bf16 v[80:95], v[200:203], v[212:215], v[80:95]
  ds_read_b64_tr_b16 v[184:185], v223 offset:61440
  ds_read_b64_tr_b16 v[186:187], v223 offset:62208
  buffer_load_dwordx4 v2, s[24:27], s11 offen offset:2048 sc1 lds
  v_mfma_f32_32x32x16_bf16 v[96:111], v[204:207], v[208:211], v[96:111]
  buffer_load_dwordx4 v2, s[24:27], s11 offen offset:3072 sc1 lds
  s_add_u32 m0, m0, 4096
  v_mfma_f32_32x32x16_bf16 v[112:127], v[204:207], v[212:215], v[112:127]
  buffer_load_dwordx4 v2, s[24:27], s33 offen sc1 lds
  s_add_u32 s11, s11, 87040
  s_waitcnt lgkmcnt(0)
  v_mfma_f32_32x32x16_bf16 v[32:47], v[176:179], v[188:191], v[32:47]
  ds_read_b128 v[208:211], v224 offset:62464
  ds_read_b64_tr_b16 v[196:197], v221 offset:64512
  v_mfma_f32_32x32x16_bf16 v[48:63], v[176:179], v[192:195], v[48:63]
  ds_read_b64_tr_b16 v[198:199], v221 offset:65280
  ds_read_b128 v[212:215], v224 offset:64512
  v_mfma_f32_32x32x16_bf16 v[64:79], v[180:183], v[188:191], v[64:79]
  ds_read_b64_tr_b16 v[200:201], v222 offset:64512
  ds_read_b64_tr_b16 v[202:203], v222 offset:65280
  v_mfma_f32_32x32x16_bf16 v[80:95], v[180:183], v[192:195], v[80:95]
  ds_read_b64_tr_b16 v[204:205], v223 offset:64512
  ds_read_b64_tr_b16 v[206:207], v223 offset:65280
  v_mfma_f32_32x32x16_bf16 v[96:111], v[184:187], v[188:191], v[96:111]
  v_mfma_f32_32x32x16_bf16 v[112:127], v[184:187], v[192:195], v[112:127]
  s_waitcnt vmcnt(10) lgkmcnt(0)
  s_barrier
  v_mfma_f32_32x32x16_bf16 v[32:47], v[196:199], v[208:211], v[32:47]
  s_add_u32 m0, s43, 61440
  s_add_u32 s33, s11, 4096
  v_mfma_f32_32x32x16_bf16 v[48:63], v[196:199], v[212:215], v[48:63]
  buffer_load_dwordx4 v2, s[24:27], s11 offen offset:0 sc1 lds
  v_mfma_f32_32x32x16_bf16 v[64:79], v[200:203], v[208:211], v[64:79]
  buffer_load_dwordx4 v2, s[24:27], s11 offen offset:1024 sc1 lds
  v_mfma_f32_32x32x16_bf16 v[80:95], v[200:203], v[212:215], v[80:95]
  buffer_load_dwordx4 v2, s[24:27], s11 offen offset:2048 sc1 lds
  v_mfma_f32_32x32x16_bf16 v[96:111], v[204:207], v[208:211], v[96:111]
  buffer_load_dwordx4 v2, s[24:27], s11 offen offset:3072 sc1 lds
  s_add_u32 m0, m0, 4096
  v_mfma_f32_32x32x16_bf16 v[112:127], v[204:207], v[212:215], v[112:127]
  buffer_load_dwordx4 v2, s[24:27], s33 offen sc1 lds
  s_add_u32 s11, s11, 87040
  s_setprio 2
  v_lshrrev_b32 v8, 5, v1
  s_mul_i32 s14, s3, 20480
  s_add_u32 s20, s70, 0x50000
  s_addc_u32 s21, s71, 0
  s_mov_b32 s22, 0x2a8000
  s_mov_b32 s23, 0x20000
  s_mov_b32 s16, s48
  s_mov_b32 s17, s49
  s_mov_b32 s18, 0x280000
  s_mov_b32 s19, 0x20000
  s_lshl_b32 s12, s10, 2
  s_add_u32 s12, s12, s3
  s_mul_i32 s12, s12, 87040
  s_add_u32 s12, s12, 20480
  s_lshl_b32 s32, s7, 1
  s_add_u32 s32, s32, s39
  s_mul_i32 s32, s32, 272
  s_mul_i32 s43, s8, 6
  s_add_u32 s32, s32, s43
  s_add_u32 s32, s32, s40
  s_add_u32 s32, s32, 40
  s_lshl_b32 s32, s32, 10
  s_add_u32 s34, s32, 139264
  s_mov_b32 s33, 0x40053526
  s_waitcnt lgkmcnt(0)
  v_mov_b32 v184, s33
  v_mov_b32 v185, s33
  v_exp_f32 v176, -v32
  v_exp_f32 v177, -v33
  v_exp_f32 v178, -v34
  v_exp_f32 v179, -v35
  v_exp_f32 v180, -v36
  v_exp_f32 v181, -v37
  v_exp_f32 v182, -v38
  v_exp_f32 v183, -v39
  v_pk_mul_f32 v[32:33], v[32:33], v[40:41]
  v_pk_mul_f32 v[34:35], v[34:35], v[42:43]
  v_pk_mul_f32 v[36:37], v[36:37], v[44:45]
  v_pk_mul_f32 v[38:39], v[38:39], v[46:47]
  v_pk_fma_f32 v[176:177], v[176:177], v[184:185], v[184:185]
  v_pk_fma_f32 v[178:179], v[178:179], v[184:185], v[184:185]
  v_pk_fma_f32 v[180:181], v[180:181], v[184:185], v[184:185]
  v_pk_fma_f32 v[182:183], v[182:183], v[184:185], v[184:185]
  v_rcp_f32 v176, v176
  v_rcp_f32 v177, v177
  v_rcp_f32 v178, v178
  v_rcp_f32 v179, v179
  v_rcp_f32 v180, v180
  v_rcp_f32 v181, v181
  v_rcp_f32 v182, v182
  v_rcp_f32 v183, v183
  v_pk_mul_f32 v[32:33], v[32:33], v[176:177]
  v_pk_mul_f32 v[34:35], v[34:35], v[178:179]
  v_pk_mul_f32 v[36:37], v[36:37], v[180:181]
  v_pk_mul_f32 v[38:39], v[38:39], v[182:183]
  v_cvt_pk_bf16_f32 v40, v32, v33
  v_cvt_pk_bf16_f32 v41, v34, v35
  v_cvt_pk_bf16_f32 v42, v36, v37
  v_cvt_pk_bf16_f32 v43, v38, v39
  buffer_store_dwordx4 v[40:43], v2, s[28:31], s32 offen offset:0 sc1
  v_exp_f32 v176, -v48
  v_exp_f32 v177, -v49
  v_exp_f32 v178, -v50
  v_exp_f32 v179, -v51
  v_exp_f32 v180, -v52
  v_exp_f32 v181, -v53
  v_exp_f32 v182, -v54
  v_exp_f32 v183, -v55
  v_pk_mul_f32 v[48:49], v[48:49], v[56:57]
  v_pk_mul_f32 v[50:51], v[50:51], v[58:59]
  v_pk_mul_f32 v[52:53], v[52:53], v[60:61]
  v_pk_mul_f32 v[54:55], v[54:55], v[62:63]
  v_pk_fma_f32 v[176:177], v[176:177], v[184:185], v[184:185]
  v_pk_fma_f32 v[178:179], v[178:179], v[184:185], v[184:185]
  v_pk_fma_f32 v[180:181], v[180:181], v[184:185], v[184:185]
  v_pk_fma_f32 v[182:183], v[182:183], v[184:185], v[184:185]
  v_rcp_f32 v176, v176
  v_rcp_f32 v177, v177
  v_rcp_f32 v178, v178
  v_rcp_f32 v179, v179
  v_rcp_f32 v180, v180
  v_rcp_f32 v181, v181
  v_rcp_f32 v182, v182
  v_rcp_f32 v183, v183
  v_pk_mul_f32 v[48:49], v[48:49], v[176:177]
  v_pk_mul_f32 v[50:51], v[50:51], v[178:179]
  v_pk_mul_f32 v[52:53], v[52:53], v[180:181]
  v_pk_mul_f32 v[54:55], v[54:55], v[182:183]
  v_cvt_pk_bf16_f32 v56, v48, v49
  v_cvt_pk_bf16_f32 v57, v50, v51
  v_cvt_pk_bf16_f32 v58, v52, v53
  v_cvt_pk_bf16_f32 v59, v54, v55
  buffer_store_dwordx4 v[56:59], v2, s[28:31], s34 offen offset:0 sc1
  v_exp_f32 v176, -v64
  v_exp_f32 v177, -v65
  v_exp_f32 v178, -v66
  v_exp_f32 v179, -v67
  v_exp_f32 v180, -v68
  v_exp_f32 v181, -v69
  v_exp_f32 v182, -v70
  v_exp_f32 v183, -v71
  v_pk_mul_f32 v[64:65], v[64:65], v[72:73]
  v_pk_mul_f32 v[66:67], v[66:67], v[74:75]
  v_pk_mul_f32 v[68:69], v[68:69], v[76:77]
  v_pk_mul_f32 v[70:71], v[70:71], v[78:79]
  v_pk_fma_f32 v[176:177], v[176:177], v[184:185], v[184:185]
  v_pk_fma_f32 v[178:179], v[178:179], v[184:185], v[184:185]
  v_pk_fma_f32 v[180:181], v[180:181], v[184:185], v[184:185]
  v_pk_fma_f32 v[182:183], v[182:183], v[184:185], v[184:185]
  v_rcp_f32 v176, v176
  v_rcp_f32 v177, v177
  v_rcp_f32 v178, v178
  v_rcp_f32 v179, v179
  v_rcp_f32 v180, v180
  v_rcp_f32 v181, v181
  v_rcp_f32 v182, v182
  v_rcp_f32 v183, v183
  v_pk_mul_f32 v[64:65], v[64:65], v[176:177]
  v_pk_mul_f32 v[66:67], v[66:67], v[178:179]
  v_pk_mul_f32 v[68:69], v[68:69], v[180:181]
  v_pk_mul_f32 v[70:71], v[70:71], v[182:183]
  v_cvt_pk_bf16_f32 v72, v64, v65
  v_cvt_pk_bf16_f32 v73, v66, v67
  v_cvt_pk_bf16_f32 v74, v68, v69
  v_cvt_pk_bf16_f32 v75, v70, v71
  buffer_store_dwordx4 v[72:75], v2, s[28:31], s32 offen offset:1024 sc1
  v_exp_f32 v176, -v80
  v_exp_f32 v177, -v81
  v_exp_f32 v178, -v82
  v_exp_f32 v179, -v83
  v_exp_f32 v180, -v84
  v_exp_f32 v181, -v85
  v_exp_f32 v182, -v86
  v_exp_f32 v183, -v87
  v_pk_mul_f32 v[80:81], v[80:81], v[88:89]
  v_pk_mul_f32 v[82:83], v[82:83], v[90:91]
  v_pk_mul_f32 v[84:85], v[84:85], v[92:93]
  v_pk_mul_f32 v[86:87], v[86:87], v[94:95]
  v_pk_fma_f32 v[176:177], v[176:177], v[184:185], v[184:185]
  v_pk_fma_f32 v[178:179], v[178:179], v[184:185], v[184:185]
  v_pk_fma_f32 v[180:181], v[180:181], v[184:185], v[184:185]
  v_pk_fma_f32 v[182:183], v[182:183], v[184:185], v[184:185]
  v_rcp_f32 v176, v176
  v_rcp_f32 v177, v177
  v_rcp_f32 v178, v178
  v_rcp_f32 v179, v179
  v_rcp_f32 v180, v180
  v_rcp_f32 v181, v181
  v_rcp_f32 v182, v182
  v_rcp_f32 v183, v183
  v_pk_mul_f32 v[80:81], v[80:81], v[176:177]
  v_pk_mul_f32 v[82:83], v[82:83], v[178:179]
  v_pk_mul_f32 v[84:85], v[84:85], v[180:181]
  v_pk_mul_f32 v[86:87], v[86:87], v[182:183]
  v_cvt_pk_bf16_f32 v88, v80, v81
  v_cvt_pk_bf16_f32 v89, v82, v83
  v_cvt_pk_bf16_f32 v90, v84, v85
  v_cvt_pk_bf16_f32 v91, v86, v87
  buffer_store_dwordx4 v[88:91], v2, s[28:31], s34 offen offset:1024 sc1
  v_exp_f32 v176, -v96
  v_exp_f32 v177, -v97
  v_exp_f32 v178, -v98
  v_exp_f32 v179, -v99
  v_exp_f32 v180, -v100
  v_exp_f32 v181, -v101
  v_exp_f32 v182, -v102
  v_exp_f32 v183, -v103
  v_pk_mul_f32 v[96:97], v[96:97], v[104:105]
  v_pk_mul_f32 v[98:99], v[98:99], v[106:107]
  v_pk_mul_f32 v[100:101], v[100:101], v[108:109]
  v_pk_mul_f32 v[102:103], v[102:103], v[110:111]
  v_pk_fma_f32 v[176:177], v[176:177], v[184:185], v[184:185]
  v_pk_fma_f32 v[178:179], v[178:179], v[184:185], v[184:185]
  v_pk_fma_f32 v[180:181], v[180:181], v[184:185], v[184:185]
  v_pk_fma_f32 v[182:183], v[182:183], v[184:185], v[184:185]
  v_rcp_f32 v176, v176
  v_rcp_f32 v177, v177
  v_rcp_f32 v178, v178
  v_rcp_f32 v179, v179
  v_rcp_f32 v180, v180
  v_rcp_f32 v181, v181
  v_rcp_f32 v182, v182
  v_rcp_f32 v183, v183
  v_pk_mul_f32 v[96:97], v[96:97], v[176:177]
  v_pk_mul_f32 v[98:99], v[98:99], v[178:179]
  v_pk_mul_f32 v[100:101], v[100:101], v[180:181]
  v_pk_mul_f32 v[102:103], v[102:103], v[182:183]
  v_cvt_pk_bf16_f32 v104, v96, v97
  v_cvt_pk_bf16_f32 v105, v98, v99
  v_cvt_pk_bf16_f32 v106, v100, v101
  v_cvt_pk_bf16_f32 v107, v102, v103
  buffer_store_dwordx4 v[104:107], v2, s[28:31], s32 offen offset:2048 sc1
  v_exp_f32 v176, -v112
  v_exp_f32 v177, -v113
  v_exp_f32 v178, -v114
  v_exp_f32 v179, -v115
  v_exp_f32 v180, -v116
  v_exp_f32 v181, -v117
  v_exp_f32 v182, -v118
  v_exp_f32 v183, -v119
  v_pk_mul_f32 v[112:113], v[112:113], v[120:121]
  v_pk_mul_f32 v[114:115], v[114:115], v[122:123]
  v_pk_mul_f32 v[116:117], v[116:117], v[124:125]
  v_pk_mul_f32 v[118:119], v[118:119], v[126:127]
  v_pk_fma_f32 v[176:177], v[176:177], v[184:185], v[184:185]
  v_pk_fma_f32 v[178:179], v[178:179], v[184:185], v[184:185]
  v_pk_fma_f32 v[180:181], v[180:181], v[184:185], v[184:185]
  v_pk_fma_f32 v[182:183], v[182:183], v[184:185], v[184:185]
  v_rcp_f32 v176, v176
  v_rcp_f32 v177, v177
  v_rcp_f32 v178, v178
  v_rcp_f32 v179, v179
  v_rcp_f32 v180, v180
  v_rcp_f32 v181, v181
  v_rcp_f32 v182, v182
  v_rcp_f32 v183, v183
  v_pk_mul_f32 v[112:113], v[112:113], v[176:177]
  v_pk_mul_f32 v[114:115], v[114:115], v[178:179]
  v_pk_mul_f32 v[116:117], v[116:117], v[180:181]
  v_pk_mul_f32 v[118:119], v[118:119], v[182:183]
  v_cvt_pk_bf16_f32 v120, v112, v113
  v_cvt_pk_bf16_f32 v121, v114, v115
  v_cvt_pk_bf16_f32 v122, v116, v117
  v_cvt_pk_bf16_f32 v123, v118, v119
  buffer_store_dwordx4 v[120:123], v2, s[28:31], s34 offen offset:2048 sc1
  v_add_u32 v10, s14, v2
  v_and_b32 v11, 15, v1
  v_lshlrev_b32 v11, 4, v11
  v_lshl_add_u32 v11, v8, 8, v11
  v_bfe_u32 v9, v1, 4, 1
  v_lshl_add_u32 v7, v9, 30, v11
  v_lshl_add_u32 v11, v9, 18, v11
  v_add_u32 v11, s14, v11
  s_lshl_b32 s35, s7, 4
  s_add_u32 s36, s35, s8
  s_lshl_b32 s36, s36, 7
  s_add_u32 s36, s36, 36864
  s_mul_i32 s24, s9, 278528
  s_mul_i32 s32, s3, 24576
  s_add_u32 s26, s24, s32
  s_add_u32 s26, s26, 40960
  s_add_u32 s27, s26, 139264
  v_and_b32 v14, 3, v1
  v_lshlrev_b32 v14, 7, v14
  v_and_b32 v6, 1, v1
  v_lshlrev_b32 v6, 7, v6
  s_lshl_b32 s32, s3, 2
  s_add_u32 s32, s32, s35
  s_lshl_b32 s32, s32, 7
  s_add_u32 s32, s32, 36864
  s_lshr_b32 s40, s3, 1
  s_and_b32 s41, s3, 1
  s_lshl_b32 s34, s9, 1
  s_add_u32 s34, s34, s40
  s_mul_i32 s34, s34, 40960
  s_mul_i32 s33, s10, 160
  s_add_u32 s43, s34, s33
  v_and_b32 v5, 31, v1
  v_mul_u32_u24 v5, 1280, v5
  s_lshl_b32 s34, s41, 6
  v_lshl_add_u32 v12, v8, 5, v5
  v_add_u32 v12, s34, v12
  s_lshl_b32 s34, s41, 3
  s_add_u32 s34, s34, 128
  v_lshl_add_u32 v13, v8, 4, v5
  v_add_u32 v13, s34, v13
  s_mul_i32 s34, s40, 10240
  s_lshl_b32 s33, s41, 12
  s_add_u32 s33, s33, s34
  v_add_u32 v15, s33, v2
  s_lshl_b32 s33, s41, 10
  s_add_u32 s33, s33, s34
  s_add_u32 s33, s33, 8192
  v_add_u32 v3, s33, v2
  s_lshl_b32 s25, s9, 3
  s_add_u32 s25, s25, s3
  s_lshl_b32 s25, s25, 7
  s_add_u32 s25, s25, 69632
  v_mov_b32 v6, 0
  s_mul_i32 s33, s3, 10240
  s_add_u32 s24, s24, s33
  s_waitcnt vmcnt(0)
  s_barrier
  s_cmp_lg_u32 s3, 0
  s_cbranch_scc1 parallel_sum__grouped_kv_mqa__swiglu_ffn__prompt_kernel_nofl35
  v_mov_b32 v16, s73
  v_mov_b32 v17, 0
  s_mov_b64 exec, 1
  buffer_store_dword v16, v17, s[44:47], s36 offen sc1
  s_mov_b64 exec, -1
parallel_sum__grouped_kv_mqa__swiglu_ffn__prompt_kernel_nofl35:
  s_add_u32 s34, s12, 61440
  s_add_u32 s35, s12, 64000
  s_mov_b32 s36, s66
  s_mov_b32 s37, s67
  s_mov_b32 s38, 0x280000
  s_mov_b32 s39, 0x20000
parallel_sum__grouped_kv_mqa__swiglu_ffn__prompt_kernel_poll36:
  buffer_load_dword v16, v14, s[44:47], s32 offen sc1
parallel_sum__grouped_kv_mqa__swiglu_ffn__prompt_kernel_pchk38:
  s_waitcnt vmcnt(0)
  v_xor_b32 v17, s73, v16
  v_cmp_ne_u32 vcc, 0, v17
  s_nop 0
  s_cmp_eq_u64 vcc, 0
  s_cbranch_scc1 parallel_sum__grouped_kv_mqa__swiglu_ffn__prompt_kernel_pdone37
  s_cmp_eq_u32 s74, 0
  s_cbranch_scc1 parallel_sum__grouped_kv_mqa__swiglu_ffn__prompt_kernel_pdone37
  s_sub_u32 s74, s74, 1
  s_sleep 1
  s_branch parallel_sum__grouped_kv_mqa__swiglu_ffn__prompt_kernel_poll36
parallel_sum__grouped_kv_mqa__swiglu_ffn__prompt_kernel_pdone37:
  s_setprio 0
  buffer_load_dwordx4 v[128:131], v2, s[28:31], s26 offen offset:0 sc1
  buffer_load_dwordx4 v[132:135], v2, s[28:31], s27 offen offset:0 sc1
  buffer_load_dwordx4 v[136:139], v2, s[28:31], s26 offen offset:1024 sc1
  buffer_load_dwordx4 v[140:143], v2, s[28:31], s27 offen offset:1024 sc1
  s_add_u32 s26, s26, 2048
  s_add_u32 s27, s27, 2048
  buffer_load_dwordx4 v[144:147], v2, s[28:31], s26 offen offset:0 sc1
  buffer_load_dwordx4 v[148:151], v2, s[28:31], s27 offen offset:0 sc1
  buffer_load_dwordx4 v[152:155], v2, s[28:31], s26 offen offset:1024 sc1
  buffer_load_dwordx4 v[156:159], v2, s[28:31], s27 offen offset:1024 sc1
  s_add_u32 s26, s26, 2048
  s_add_u32 s27, s27, 2048
  buffer_load_dwordx4 v[160:163], v2, s[28:31], s26 offen offset:0 sc1
  buffer_load_dwordx4 v[164:167], v2, s[28:31], s27 offen offset:0 sc1
  buffer_load_dwordx4 v[168:171], v2, s[28:31], s26 offen offset:1024 sc1
  buffer_load_dwordx4 v[172:175], v2, s[28:31], s27 offen offset:1024 sc1
  s_add_u32 s26, s26, 2048
  s_add_u32 s27, s27, 2048
  buffer_load_dwordx4 v[176:179], v2, s[28:31], s26 offen offset:0 sc1
  buffer_load_dwordx4 v[180:183], v2, s[28:31], s27 offen offset:0 sc1
  buffer_load_dwordx4 v[184:187], v2, s[28:31], s26 offen offset:1024 sc1
  buffer_load_dwordx4 v[188:191], v2, s[28:31], s27 offen offset:1024 sc1
  s_add_u32 s26, s26, 2048
  s_add_u32 s27, s27, 2048
  s_mov_b32 s42, 0
  s_setprio 0
  ds_read_b128 v[208:211], v10 offset:0
  ds_read_b128 v[212:215], v10 offset:1024
  ds_read_b128 v[216:219], v11 offset:2048
  s_waitcnt vmcnt(14) lgkmcnt(0)
  v_mfma_f32_32x32x16_bf16 v[32:47], v[208:211], v[128:131], 0
  ds_read_b128 v[220:223], v10 offset:2560
  v_mfma_f32_32x32x16_bf16 v[80:95], v[208:211], v[132:135], 0
  ds_read_b128 v[224:227], v10 offset:3584
  v_mfma_f32_32x32x16_bf16 v[48:63], v[212:215], v[128:131], 0
  ds_read_b128 v[228:231], v11 offset:4608
  v_mfma_f32_32x32x16_bf16 v[96:111], v[212:215], v[132:135], 0
  v_mfma_f32_32x32x16_bf16 v[64:79], v[216:219], v[128:131], 0
  v_mfma_f32_32x32x16_bf16 v[112:127], v[216:219], v[132:135], 0
  s_waitcnt vmcnt(0)
  buffer_load_dwordx4 v[20:23], v2, s[20:23], s34 offen offset:0 sc1
  buffer_load_dwordx4 v[24:27], v2, s[20:23], s34 offen offset:1024 sc1
  buffer_load_dwordx4 v[28:31], v7, s[20:23], s34 offen offset:2048 sc1
  buffer_load_dwordx4 v[244:247], v2, s[20:23], s35 offen offset:0 sc1
  buffer_load_dwordx4 v[248:251], v2, s[20:23], s35 offen offset:1024 sc1
  buffer_load_dwordx4 v[252:255], v7, s[20:23], s35 offen offset:2048 sc1
  buffer_load_dwordx4 v[232:235], v12, s[16:19], s43 offen
  buffer_load_dwordx4 v[236:239], v12, s[16:19], s43 offen offset:16
  buffer_load_dwordx2 v[240:241], v13, s[16:19], s43 offen
  s_branch parallel_sum__grouped_kv_mqa__swiglu_ffn__prompt_kernel_dnm40
.p2align 6
parallel_sum__grouped_kv_mqa__swiglu_ffn__prompt_kernel_dn39:
  s_waitcnt lgkmcnt(0)
  v_mfma_f32_32x32x16_bf16 v[32:47], v[208:211], v[128:131], v[32:47]
  ds_read_b128 v[220:223], v10 offset:2560
  v_mfma_f32_32x32x16_bf16 v[80:95], v[208:211], v[132:135], v[80:95]
  ds_read_b128 v[224:227], v10 offset:3584
  v_mfma_f32_32x32x16_bf16 v[48:63], v[212:215], v[128:131], v[48:63]
  ds_read_b128 v[228:231], v11 offset:4608
  v_mfma_f32_32x32x16_bf16 v[96:111], v[212:215], v[132:135], v[96:111]
  s_cmp_eq_u32 s42, 2
  s_cselect_b32 s26, 0x7ff00000, s26
  s_cselect_b32 s27, 0x7ff00000, s27
  v_mfma_f32_32x32x16_bf16 v[64:79], v[216:219], v[128:131], v[64:79]
  v_mfma_f32_32x32x16_bf16 v[112:127], v[216:219], v[132:135], v[112:127]
parallel_sum__grouped_kv_mqa__swiglu_ffn__prompt_kernel_dnm40:
  s_waitcnt vmcnt(18) lgkmcnt(0)
  v_mfma_f32_32x32x16_bf16 v[32:47], v[220:223], v[136:139], v[32:47]
  ds_read_b128 v[208:211], v10 offset:5120
  s_add_u32 m0, s14, 0
  s_add_u32 s33, s12, 4096
  v_mfma_f32_32x32x16_bf16 v[80:95], v[220:223], v[140:143], v[80:95]
  ds_read_b128 v[212:215], v10 offset:6144
  buffer_load_dwordx4 v2, s[20:23], s12 offen offset:0 sc1 lds
  v_mfma_f32_32x32x16_bf16 v[48:63], v[224:227], v[136:139], v[48:63]
  ds_read_b128 v[216:219], v11 offset:7168
  buffer_load_dwordx4 v2, s[20:23], s12 offen offset:1024 sc1 lds
  v_mfma_f32_32x32x16_bf16 v[96:111], v[224:227], v[140:143], v[96:111]
  buffer_load_dwordx4 v2, s[20:23], s12 offen offset:2048 sc1 lds
  buffer_load_dwordx4 v2, s[20:23], s12 offen offset:3072 sc1 lds
  s_add_u32 m0, m0, 4096
  v_mfma_f32_32x32x16_bf16 v[64:79], v[228:231], v[136:139], v[64:79]
  buffer_load_dwordx4 v2, s[20:23], s33 offen sc1 lds
  s_add_u32 s12, s12, 5120
  v_mfma_f32_32x32x16_bf16 v[112:127], v[228:231], v[140:143], v[112:127]
  buffer_load_dwordx4 v[128:131], v2, s[28:31], s26 offen offset:0 sc1
  buffer_load_dwordx4 v[132:135], v2, s[28:31], s27 offen offset:0 sc1
  buffer_load_dwordx4 v[136:139], v2, s[28:31], s26 offen offset:1024 sc1
  buffer_load_dwordx4 v[140:143], v2, s[28:31], s27 offen offset:1024 sc1
  s_add_u32 s26, s26, 2048
  s_add_u32 s27, s27, 2048
  s_waitcnt lgkmcnt(0)
  v_mfma_f32_32x32x16_bf16 v[32:47], v[208:211], v[144:147], v[32:47]
  ds_read_b128 v[220:223], v10 offset:7680
  v_mfma_f32_32x32x16_bf16 v[80:95], v[208:211], v[148:151], v[80:95]
  ds_read_b128 v[224:227], v10 offset:8704
  v_mfma_f32_32x32x16_bf16 v[48:63], v[212:215], v[144:147], v[48:63]
  ds_read_b128 v[228:231], v11 offset:9728
  v_mfma_f32_32x32x16_bf16 v[96:111], v[212:215], v[148:151], v[96:111]
  v_mfma_f32_32x32x16_bf16 v[64:79], v[216:219], v[144:147], v[64:79]
  v_mfma_f32_32x32x16_bf16 v[112:127], v[216:219], v[148:151], v[112:127]
  s_waitcnt vmcnt(18) lgkmcnt(0)
  v_mfma_f32_32x32x16_bf16 v[32:47], v[220:223], v[152:155], v[32:47]
  ds_read_b128 v[208:211], v10 offset:10240
  s_add_u32 m0, s14, 5120
  s_add_u32 s33, s12, 4096
  v_mfma_f32_32x32x16_bf16 v[80:95], v[220:223], v[156:159], v[80:95]
  ds_read_b128 v[212:215], v10 offset:11264
  buffer_load_dwordx4 v2, s[20:23], s12 offen offset:0 sc1 lds
  v_mfma_f32_32x32x16_bf16 v[48:63], v[224:227], v[152:155], v[48:63]
  ds_read_b128 v[216:219], v11 offset:12288
  buffer_load_dwordx4 v2, s[20:23], s12 offen offset:1024 sc1 lds
  v_mfma_f32_32x32x16_bf16 v[96:111], v[224:227], v[156:159], v[96:111]
  buffer_load_dwordx4 v2, s[20:23], s12 offen offset:2048 sc1 lds
  buffer_load_dwordx4 v2, s[20:23], s12 offen offset:3072 sc1 lds
  s_add_u32 m0, m0, 4096
  v_mfma_f32_32x32x16_bf16 v[64:79], v[228:231], v[152:155], v[64:79]
  buffer_load_dwordx4 v2, s[20:23], s33 offen sc1 lds
  s_add_u32 s12, s12, 5120
  v_mfma_f32_32x32x16_bf16 v[112:127], v[228:231], v[156:159], v[112:127]
  buffer_load_dwordx4 v[144:147], v2, s[28:31], s26 offen offset:0 sc1
  buffer_load_dwordx4 v[148:151], v2, s[28:31], s27 offen offset:0 sc1
  buffer_load_dwordx4 v[152:155], v2, s[28:31], s26 offen offset:1024 sc1
  buffer_load_dwordx4 v[156:159], v2, s[28:31], s27 offen offset:1024 sc1
  s_add_u32 s26, s26, 2048
  s_add_u32 s27, s27, 2048
  s_waitcnt lgkmcnt(0)
  v_mfma_f32_32x32x16_bf16 v[32:47], v[208:211], v[160:163], v[32:47]
  ds_read_b128 v[220:223], v10 offset:12800
  v_mfma_f32_32x32x16_bf16 v[80:95], v[208:211], v[164:167], v[80:95]
  ds_read_b128 v[224:227], v10 offset:13824
  v_mfma_f32_32x32x16_bf16 v[48:63], v[212:215], v[160:163], v[48:63]
  ds_read_b128 v[228:231], v11 offset:14848
  v_mfma_f32_32x32x16_bf16 v[96:111], v[212:215], v[164:167], v[96:111]
  v_mfma_f32_32x32x16_bf16 v[64:79], v[216:219], v[160:163], v[64:79]
  v_mfma_f32_32x32x16_bf16 v[112:127], v[216:219], v[164:167], v[112:127]
  s_waitcnt vmcnt(18) lgkmcnt(0)
  v_mfma_f32_32x32x16_bf16 v[32:47], v[220:223], v[168:171], v[32:47]
  ds_read_b128 v[208:211], v10 offset:15360
  s_add_u32 m0, s14, 10240
  s_add_u32 s33, s12, 4096
  v_mfma_f32_32x32x16_bf16 v[80:95], v[220:223], v[172:175], v[80:95]
  ds_read_b128 v[212:215], v10 offset:16384
  buffer_load_dwordx4 v2, s[20:23], s12 offen offset:0 sc1 lds
  v_mfma_f32_32x32x16_bf16 v[48:63], v[224:227], v[168:171], v[48:63]
  ds_read_b128 v[216:219], v11 offset:17408
  buffer_load_dwordx4 v2, s[20:23], s12 offen offset:1024 sc1 lds
  v_mfma_f32_32x32x16_bf16 v[96:111], v[224:227], v[172:175], v[96:111]
  buffer_load_dwordx4 v2, s[20:23], s12 offen offset:2048 sc1 lds
  buffer_load_dwordx4 v2, s[20:23], s12 offen offset:3072 sc1 lds
  s_add_u32 m0, m0, 4096
  v_mfma_f32_32x32x16_bf16 v[64:79], v[228:231], v[168:171], v[64:79]
  buffer_load_dwordx4 v2, s[20:23], s33 offen sc1 lds
  s_add_u32 s12, s12, 5120
  v_mfma_f32_32x32x16_bf16 v[112:127], v[228:231], v[172:175], v[112:127]
  buffer_load_dwordx4 v[160:163], v2, s[28:31], s26 offen offset:0 sc1
  buffer_load_dwordx4 v[164:167], v2, s[28:31], s27 offen offset:0 sc1
  buffer_load_dwordx4 v[168:171], v2, s[28:31], s26 offen offset:1024 sc1
  buffer_load_dwordx4 v[172:175], v2, s[28:31], s27 offen offset:1024 sc1
  s_add_u32 s26, s26, 2048
  s_add_u32 s27, s27, 2048
  s_waitcnt lgkmcnt(0)
  v_mfma_f32_32x32x16_bf16 v[32:47], v[208:211], v[176:179], v[32:47]
  ds_read_b128 v[220:223], v10 offset:17920
  v_mfma_f32_32x32x16_bf16 v[80:95], v[208:211], v[180:183], v[80:95]
  ds_read_b128 v[224:227], v10 offset:18944
  v_mfma_f32_32x32x16_bf16 v[48:63], v[212:215], v[176:179], v[48:63]
  ds_read_b128 v[228:231], v11 offset:19968
  v_mfma_f32_32x32x16_bf16 v[96:111], v[212:215], v[180:183], v[96:111]
  v_mfma_f32_32x32x16_bf16 v[64:79], v[216:219], v[176:179], v[64:79]
  v_mfma_f32_32x32x16_bf16 v[112:127], v[216:219], v[180:183], v[112:127]
  s_waitcnt vmcnt(18) lgkmcnt(0)
  v_mfma_f32_32x32x16_bf16 v[32:47], v[220:223], v[184:187], v[32:47]
  ds_read_b128 v[208:211], v10 offset:0
  s_add_u32 m0, s14, 15360
  s_add_u32 s33, s12, 4096
  v_mfma_f32_32x32x16_bf16 v[80:95], v[220:223], v[188:191], v[80:95]
  ds_read_b128 v[212:215], v10 offset:1024
  buffer_load_dwordx4 v2, s[20:23], s12 offen offset:0 sc1 lds
  v_mfma_f32_32x32x16_bf16 v[48:63], v[224:227], v[184:187], v[48:63]
  ds_read_b128 v[216:219], v11 offset:2048
  buffer_load_dwordx4 v2, s[20:23], s12 offen offset:1024 sc1 lds
  v_mfma_f32_32x32x16_bf16 v[96:111], v[224:227], v[188:191], v[96:111]
  buffer_load_dwordx4 v2, s[20:23], s12 offen offset:2048 sc1 lds
  buffer_load_dwordx4 v2, s[20:23], s12 offen offset:3072 sc1 lds
  s_add_u32 m0, m0, 4096
  v_mfma_f32_32x32x16_bf16 v[64:79], v[228:231], v[184:187], v[64:79]
  buffer_load_dwordx4 v2, s[20:23], s33 offen sc1 lds
  s_add_u32 s12, s12, 5120
  v_mfma_f32_32x32x16_bf16 v[112:127], v[228:231], v[188:191], v[112:127]
  buffer_load_dwordx4 v[176:179], v2, s[28:31], s26 offen offset:0 sc1
  buffer_load_dwordx4 v[180:183], v2, s[28:31], s27 offen offset:0 sc1
  buffer_load_dwordx4 v[184:187], v2, s[28:31], s26 offen offset:1024 sc1
  buffer_load_dwordx4 v[188:191], v2, s[28:31], s27 offen offset:1024 sc1
  s_add_u32 s26, s26, 2048
  s_add_u32 s27, s27, 2048
  s_add_u32 s42, s42, 1
  s_cmp_lt_u32 s42, 3
  s_cbranch_scc1 parallel_sum__grouped_kv_mqa__swiglu_ffn__prompt_kernel_dn39
  s_setprio 2
  ds_read_b128 v[220:223], v10 offset:2560
  ds_read_b128 v[224:227], v10 offset:3584
  ds_read_b128 v[228:231], v11 offset:4608
parallel_sum__grouped_kv_mqa__swiglu_ffn__prompt_kernel_poll41:
  buffer_load_dword v16, v6, s[44:47], s25 offen sc1
  buffer_load_dword v18, v6, s[44:47], s25 offen offset:512 sc1
parallel_sum__grouped_kv_mqa__swiglu_ffn__prompt_kernel_pchk43:
  s_waitcnt vmcnt(0)
  v_xor_b32 v17, s73, v16
  v_cmp_ne_u32 vcc, 0, v17
  s_nop 0
  s_cmp_eq_u64 vcc, 0
  s_cbranch_scc1 parallel_sum__grouped_kv_mqa__swiglu_ffn__prompt_kernel_pdone42
  s_cmp_eq_u32 s74, 0
  s_cbranch_scc1 parallel_sum__grouped_kv_mqa__swiglu_ffn__prompt_kernel_pdone42
  s_sub_u32 s74, s74, 1
  s_sleep 1
  s_branch parallel_sum__grouped_kv_mqa__swiglu_ffn__prompt_kernel_poll41
parallel_sum__grouped_kv_mqa__swiglu_ffn__prompt_kernel_pdone42:
  s_add_u32 s26, s24, 0
  buffer_load_dwordx4 v[128:131], v2, s[28:31], s26 offen sc1
  s_add_u32 s26, s24, 139264
  buffer_load_dwordx4 v[168:171], v2, s[28:31], s26 offen sc1
  s_add_u32 s26, s24, 1024
  buffer_load_dwordx4 v[132:135], v2, s[28:31], s26 offen sc1
  s_add_u32 s26, s24, 140288
  buffer_load_dwordx4 v[172:175], v2, s[28:31], s26 offen sc1
  s_add_u32 s26, s24, 2048
  buffer_load_dwordx4 v[136:139], v2, s[28:31], s26 offen sc1
  s_add_u32 s26, s24, 141312
  buffer_load_dwordx4 v[176:179], v2, s[28:31], s26 offen sc1
  s_add_u32 s26, s24, 3072
  buffer_load_dwordx4 v[140:143], v2, s[28:31], s26 offen sc1
  s_add_u32 s26, s24, 142336
  buffer_load_dwordx4 v[180:183], v2, s[28:31], s26 offen sc1
  s_add_u32 s26, s24, 4096
  buffer_load_dwordx4 v[144:147], v2, s[28:31], s26 offen sc1
  s_add_u32 s26, s24, 143360
  buffer_load_dwordx4 v[184:187], v2, s[28:31], s26 offen sc1
  v_cmp_ne_u32 vcc, s73, v18
  s_nop 0
  s_cmp_eq_u64 vcc, 0
  s_cbranch_scc1 parallel_sum__grouped_kv_mqa__swiglu_ffn__prompt_kernel_both44
  buffer_load_dword v18, v6, s[44:47], s25 offen offset:512 sc1
  s_waitcnt vmcnt(9) lgkmcnt(3)
  v_mfma_f32_32x32x16_bf16 v[32:47], v[208:211], v[128:131], v[32:47]
  v_mfma_f32_32x32x16_bf16 v[80:95], v[208:211], v[168:171], v[80:95]
  v_mfma_f32_32x32x16_bf16 v[48:63], v[212:215], v[128:131], v[48:63]
  v_mfma_f32_32x32x16_bf16 v[96:111], v[212:215], v[168:171], v[96:111]
  v_mfma_f32_32x32x16_bf16 v[64:79], v[216:219], v[128:131], v[64:79]
  v_mfma_f32_32x32x16_bf16 v[112:127], v[216:219], v[168:171], v[112:127]
  ds_read_b128 v[208:211], v10 offset:5120
  ds_read_b128 v[212:215], v10 offset:6144
  ds_read_b128 v[216:219], v11 offset:7168
  s_waitcnt vmcnt(7) lgkmcnt(3)
  v_mfma_f32_32x32x16_bf16 v[32:47], v[220:223], v[132:135], v[32:47]
  v_mfma_f32_32x32x16_bf16 v[80:95], v[220:223], v[172:175], v[80:95]
  v_mfma_f32_32x32x16_bf16 v[48:63], v[224:227], v[132:135], v[48:63]
  v_mfma_f32_32x32x16_bf16 v[96:111], v[224:227], v[172:175], v[96:111]
  v_mfma_f32_32x32x16_bf16 v[64:79], v[228:231], v[132:135], v[64:79]
  v_mfma_f32_32x32x16_bf16 v[112:127], v[228:231], v[172:175], v[112:127]
  ds_read_b128 v[220:223], v10 offset:7680
  ds_read_b128 v[224:227], v10 offset:8704
  ds_read_b128 v[228:231], v11 offset:9728
  s_waitcnt vmcnt(5) lgkmcnt(3)
  v_mfma_f32_32x32x16_bf16 v[32:47], v[208:211], v[136:139], v[32:47]
  v_mfma_f32_32x32x16_bf16 v[80:95], v[208:211], v[176:179], v[80:95]
  v_mfma_f32_32x32x16_bf16 v[48:63], v[212:215], v[136:139], v[48:63]
  v_mfma_f32_32x32x16_bf16 v[96:111], v[212:215], v[176:179], v[96:111]
  v_mfma_f32_32x32x16_bf16 v[64:79], v[216:219], v[136:139], v[64:79]
  v_mfma_f32_32x32x16_bf16 v[112:127], v[216:219], v[176:179], v[112:127]
  ds_read_b128 v[208:211], v10 offset:10240
  ds_read_b128 v[212:215], v10 offset:11264
  ds_read_b128 v[216:219], v11 offset:12288
  s_waitcnt vmcnt(3) lgkmcnt(3)
  v_mfma_f32_32x32x16_bf16 v[32:47], v[220:223], v[140:143], v[32:47]
  v_mfma_f32_32x32x16_bf16 v[80:95], v[220:223], v[180:183], v[80:95]
  v_mfma_f32_32x32x16_bf16 v[48:63], v[224:227], v[140:143], v[48:63]
  v_mfma_f32_32x32x16_bf16 v[96:111], v[224:227], v[180:183], v[96:111]
  v_mfma_f32_32x32x16_bf16 v[64:79], v[228:231], v[140:143], v[64:79]
  v_mfma_f32_32x32x16_bf16 v[112:127], v[228:231], v[180:183], v[112:127]
  ds_read_b128 v[220:223], v10 offset:12800
  ds_read_b128 v[224:227], v10 offset:13824
  ds_read_b128 v[228:231], v11 offset:14848
  s_waitcnt vmcnt(1) lgkmcnt(3)
  v_mfma_f32_32x32x16_bf16 v[32:47], v[208:211], v[144:147], v[32:47]
  v_mfma_f32_32x32x16_bf16 v[80:95], v[208:211], v[184:187], v[80:95]
  v_mfma_f32_32x32x16_bf16 v[48:63], v[212:215], v[144:147], v[48:63]
  v_mfma_f32_32x32x16_bf16 v[96:111], v[212:215], v[184:187], v[96:111]
  v_mfma_f32_32x32x16_bf16 v[64:79], v[216:219], v[144:147], v[64:79]
  v_mfma_f32_32x32x16_bf16 v[112:127], v[216:219], v[184:187], v[112:127]
  ds_read_b128 v[208:211], v10 offset:15360
  ds_read_b128 v[212:215], v10 offset:16384
  ds_read_b128 v[216:219], v11 offset:17408
  s_branch parallel_sum__grouped_kv_mqa__swiglu_ffn__prompt_kernel_pchk48
parallel_sum__grouped_kv_mqa__swiglu_ffn__prompt_kernel_poll46:
  buffer_load_dword v18, v6, s[44:47], s25 offen offset:512 sc1
parallel_sum__grouped_kv_mqa__swiglu_ffn__prompt_kernel_pchk48:
  s_waitcnt vmcnt(0)
  v_xor_b32 v17, s73, v18
  v_cmp_ne_u32 vcc, 0, v17
  s_nop 0
  s_cmp_eq_u64 vcc, 0
  s_cbranch_scc1 parallel_sum__grouped_kv_mqa__swiglu_ffn__prompt_kernel_pdone47
  s_cmp_eq_u32 s74, 0
  s_cbranch_scc1 parallel_sum__grouped_kv_mqa__swiglu_ffn__prompt_kernel_pdone47
  s_sub_u32 s74, s74, 1
  s_sleep 1
  s_branch parallel_sum__grouped_kv_mqa__swiglu_ffn__prompt_kernel_poll46
parallel_sum__grouped_kv_mqa__swiglu_ffn__prompt_kernel_pdone47:
  s_add_u32 s26, s24, 5120
  buffer_load_dwordx4 v[148:151], v2, s[28:31], s26 offen sc1
  s_add_u32 s26, s24, 6144
  buffer_load_dwordx4 v[152:155], v2, s[28:31], s26 offen sc1
  s_add_u32 s26, s24, 7168
  buffer_load_dwordx4 v[156:159], v2, s[28:31], s26 offen sc1
  s_add_u32 s26, s24, 8192
  buffer_load_dwordx4 v[160:163], v2, s[28:31], s26 offen sc1
  s_add_u32 s26, s24, 9216
  buffer_load_dwordx4 v[164:167], v2, s[28:31], s26 offen sc1
  s_add_u32 s26, s24, 144384
  buffer_load_dwordx4 v[188:191], v2, s[28:31], s26 offen sc1
  s_add_u32 s26, s24, 145408
  buffer_load_dwordx4 v[192:195], v2, s[28:31], s26 offen sc1
  s_add_u32 s26, s24, 146432
  buffer_load_dwordx4 v[196:199], v2, s[28:31], s26 offen sc1
  s_add_u32 s26, s24, 147456
  buffer_load_dwordx4 v[200:203], v2, s[28:31], s26 offen sc1
  s_add_u32 s26, s24, 148480
  buffer_load_dwordx4 v[204:207], v2, s[28:31], s26 offen sc1
  s_branch parallel_sum__grouped_kv_mqa__swiglu_ffn__prompt_kernel_join45
parallel_sum__grouped_kv_mqa__swiglu_ffn__prompt_kernel_both44:
  s_add_u32 s26, s24, 5120
  buffer_load_dwordx4 v[148:151], v2, s[28:31], s26 offen sc1
  s_add_u32 s26, s24, 6144
  buffer_load_dwordx4 v[152:155], v2, s[28:31], s26 offen sc1
  s_add_u32 s26, s24, 7168
  buffer_load_dwordx4 v[156:159], v2, s[28:31], s26 offen sc1
  s_add_u32 s26, s24, 8192
  buffer_load_dwordx4 v[160:163], v2, s[28:31], s26 offen sc1
  s_add_u32 s26, s24, 9216
  buffer_load_dwordx4 v[164:167], v2, s[28:31], s26 offen sc1
  s_add_u32 s26, s24, 144384
  buffer_load_dwordx4 v[188:191], v2, s[28:31], s26 offen sc1
  s_add_u32 s26, s24, 145408
  buffer_load_dwordx4 v[192:195], v2, s[28:31], s26 offen sc1
  s_add_u32 s26, s24, 146432
  buffer_load_dwordx4 v[196:199], v2, s[28:31], s26 offen sc1
  s_add_u32 s26, s24, 147456
  buffer_load_dwordx4 v[200:203], v2, s[28:31], s26 offen sc1
  s_add_u32 s26, s24, 148480
  buffer_load_dwordx4 v[204:207], v2, s[28:31], s26 offen sc1
  s_waitcnt vmcnt(18) lgkmcnt(3)
  v_mfma_f32_32x32x16_bf16 v[32:47], v[208:211], v[128:131], v[32:47]
  v_mfma_f32_32x32x16_bf16 v[80:95], v[208:211], v[168:171], v[80:95]
  v_mfma_f32_32x32x16_bf16 v[48:63], v[212:215], v[128:131], v[48:63]
  v_mfma_f32_32x32x16_bf16 v[96:111], v[212:215], v[168:171], v[96:111]
  v_mfma_f32_32x32x16_bf16 v[64:79], v[216:219], v[128:131], v[64:79]
  v_mfma_f32_32x32x16_bf16 v[112:127], v[216:219], v[168:171], v[112:127]
  ds_read_b128 v[208:211], v10 offset:5120
  ds_read_b128 v[212:215], v10 offset:6144
  ds_read_b128 v[216:219], v11 offset:7168
  s_waitcnt vmcnt(16) lgkmcnt(3)
  v_mfma_f32_32x32x16_bf16 v[32:47], v[220:223], v[132:135], v[32:47]
  v_mfma_f32_32x32x16_bf16 v[80:95], v[220:223], v[172:175], v[80:95]
  v_mfma_f32_32x32x16_bf16 v[48:63], v[224:227], v[132:135], v[48:63]
  v_mfma_f32_32x32x16_bf16 v[96:111], v[224:227], v[172:175], v[96:111]
  v_mfma_f32_32x32x16_bf16 v[64:79], v[228:231], v[132:135], v[64:79]
  v_mfma_f32_32x32x16_bf16 v[112:127], v[228:231], v[172:175], v[112:127]
  ds_read_b128 v[220:223], v10 offset:7680
  ds_read_b128 v[224:227], v10 offset:8704
  ds_read_b128 v[228:231], v11 offset:9728
  s_waitcnt vmcnt(14) lgkmcnt(3)
  v_mfma_f32_32x32x16_bf16 v[32:47], v[208:211], v[136:139], v[32:47]
  v_mfma_f32_32x32x16_bf16 v[80:95], v[208:211], v[176:179], v[80:95]
  v_mfma_f32_32x32x16_bf16 v[48:63], v[212:215], v[136:139], v[48:63]
  v_mfma_f32_32x32x16_bf16 v[96:111], v[212:215], v[176:179], v[96:111]
  v_mfma_f32_32x32x16_bf16 v[64:79], v[216:219], v[136:139], v[64:79]
  v_mfma_f32_32x32x16_bf16 v[112:127], v[216:219], v[176:179], v[112:127]
  ds_read_b128 v[208:211], v10 offset:10240
  ds_read_b128 v[212:215], v10 offset:11264
  ds_read_b128 v[216:219], v11 offset:12288
  s_waitcnt vmcnt(12) lgkmcnt(3)
  v_mfma_f32_32x32x16_bf16 v[32:47], v[220:223], v[140:143], v[32:47]
  v_mfma_f32_32x32x16_bf16 v[80:95], v[220:223], v[180:183], v[80:95]
  v_mfma_f32_32x32x16_bf16 v[48:63], v[224:227], v[140:143], v[48:63]
  v_mfma_f32_32x32x16_bf16 v[96:111], v[224:227], v[180:183], v[96:111]
  v_mfma_f32_32x32x16_bf16 v[64:79], v[228:231], v[140:143], v[64:79]
  v_mfma_f32_32x32x16_bf16 v[112:127], v[228:231], v[180:183], v[112:127]
  ds_read_b128 v[220:223], v10 offset:12800
  ds_read_b128 v[224:227], v10 offset:13824
  ds_read_b128 v[228:231], v11 offset:14848
  s_waitcnt vmcnt(10) lgkmcnt(3)
  v_mfma_f32_32x32x16_bf16 v[32:47], v[208:211], v[144:147], v[32:47]
  v_mfma_f32_32x32x16_bf16 v[80:95], v[208:211], v[184:187], v[80:95]
  v_mfma_f32_32x32x16_bf16 v[48:63], v[212:215], v[144:147], v[48:63]
  v_mfma_f32_32x32x16_bf16 v[96:111], v[212:215], v[184:187], v[96:111]
  v_mfma_f32_32x32x16_bf16 v[64:79], v[216:219], v[144:147], v[64:79]
  v_mfma_f32_32x32x16_bf16 v[112:127], v[216:219], v[184:187], v[112:127]
  ds_read_b128 v[208:211], v10 offset:15360
  ds_read_b128 v[212:215], v10 offset:16384
  ds_read_b128 v[216:219], v11 offset:17408
parallel_sum__grouped_kv_mqa__swiglu_ffn__prompt_kernel_join45:
  s_waitcnt vmcnt(9) lgkmcnt(3)
  v_mfma_f32_32x32x16_bf16 v[32:47], v[220:223], v[148:151], v[32:47]
  v_mfma_f32_32x32x16_bf16 v[48:63], v[224:227], v[148:151], v[48:63]
  v_mfma_f32_32x32x16_bf16 v[64:79], v[228:231], v[148:151], v[64:79]
  ds_read_b128 v[220:223], v10 offset:17920
  ds_read_b128 v[224:227], v10 offset:18944
  ds_read_b128 v[228:231], v11 offset:19968
  s_waitcnt vmcnt(8) lgkmcnt(3)
  v_mfma_f32_32x32x16_bf16 v[32:47], v[208:211], v[152:155], v[32:47]
  v_mfma_f32_32x32x16_bf16 v[48:63], v[212:215], v[152:155], v[48:63]
  v_mfma_f32_32x32x16_bf16 v[64:79], v[216:219], v[152:155], v[64:79]
  ds_read_b128 v[208:211], v10 offset:12800
  ds_read_b128 v[212:215], v10 offset:13824
  ds_read_b128 v[216:219], v11 offset:14848
  s_waitcnt vmcnt(7) lgkmcnt(3)
  v_mfma_f32_32x32x16_bf16 v[32:47], v[220:223], v[156:159], v[32:47]
  v_mfma_f32_32x32x16_bf16 v[48:63], v[224:227], v[156:159], v[48:63]
  v_mfma_f32_32x32x16_bf16 v[64:79], v[228:231], v[156:159], v[64:79]
  ds_read_b128 v[220:223], v10 offset:15360
  ds_read_b128 v[224:227], v10 offset:16384
  ds_read_b128 v[228:231], v11 offset:17408
  s_waitcnt vmcnt(6)
  v_mfma_f32_32x32x16_bf16 v[32:47], v[20:23], v[160:163], v[32:47]
  v_mfma_f32_32x32x16_bf16 v[48:63], v[24:27], v[160:163], v[48:63]
  v_mfma_f32_32x32x16_bf16 v[64:79], v[28:31], v[160:163], v[64:79]
  s_waitcnt vmcnt(5)
  v_mfma_f32_32x32x16_bf16 v[32:47], v[244:247], v[164:167], v[32:47]
  v_mfma_f32_32x32x16_bf16 v[48:63], v[248:251], v[164:167], v[48:63]
  v_mfma_f32_32x32x16_bf16 v[64:79], v[252:255], v[164:167], v[64:79]
  s_waitcnt vmcnt(4) lgkmcnt(3)
  v_mfma_f32_32x32x16_bf16 v[80:95], v[208:211], v[188:191], v[80:95]
  v_mfma_f32_32x32x16_bf16 v[96:111], v[212:215], v[188:191], v[96:111]
  v_mfma_f32_32x32x16_bf16 v[112:127], v[216:219], v[188:191], v[112:127]
  ds_read_b128 v[208:211], v10 offset:17920
  ds_read_b128 v[212:215], v10 offset:18944
  ds_read_b128 v[216:219], v11 offset:19968
  s_waitcnt vmcnt(3) lgkmcnt(3)
  v_mfma_f32_32x32x16_bf16 v[80:95], v[220:223], v[192:195], v[80:95]
  s_nop 0
  ds_write_b128 v10, v[32:35] offset:0
  v_mfma_f32_32x32x16_bf16 v[96:111], v[224:227], v[192:195], v[96:111]
  ds_write_b128 v10, v[36:39] offset:1024
  v_mfma_f32_32x32x16_bf16 v[112:127], v[228:231], v[192:195], v[112:127]
  ds_write_b128 v10, v[40:43] offset:2048
  s_waitcnt vmcnt(2) lgkmcnt(3)
  v_mfma_f32_32x32x16_bf16 v[80:95], v[208:211], v[196:199], v[80:95]
  ds_write_b128 v10, v[44:47] offset:3072
  v_mfma_f32_32x32x16_bf16 v[96:111], v[212:215], v[196:199], v[96:111]
  ds_write_b128 v10, v[48:51] offset:4096
  v_mfma_f32_32x32x16_bf16 v[112:127], v[216:219], v[196:199], v[112:127]
  ds_write_b128 v10, v[52:55] offset:5120
  s_waitcnt vmcnt(1)
  v_mfma_f32_32x32x16_bf16 v[80:95], v[20:23], v[200:203], v[80:95]
  ds_write_b128 v10, v[56:59] offset:6144
  v_mfma_f32_32x32x16_bf16 v[96:111], v[24:27], v[200:203], v[96:111]
  ds_write_b128 v10, v[60:63] offset:7168
  v_mfma_f32_32x32x16_bf16 v[112:127], v[28:31], v[200:203], v[112:127]
  ds_write_b128 v10, v[64:67] offset:8192
  s_waitcnt vmcnt(0)
  v_mfma_f32_32x32x16_bf16 v[80:95], v[244:247], v[204:207], v[80:95]
  ds_write_b128 v10, v[68:71] offset:9216
  v_mfma_f32_32x32x16_bf16 v[96:111], v[248:251], v[204:207], v[96:111]
  v_mfma_f32_32x32x16_bf16 v[112:127], v[252:255], v[204:207], v[112:127]
  s_nop 8
  ds_write_b128 v10, v[80:83] offset:10240
  ds_write_b128 v10, v[84:87] offset:11264
  ds_write_b128 v10, v[88:91] offset:12288
  ds_write_b128 v10, v[92:95] offset:13312
  ds_write_b128 v10, v[96:99] offset:14336
  ds_write_b128 v10, v[100:103] offset:15360
  ds_write_b128 v10, v[104:107] offset:16384
  ds_write_b128 v10, v[108:111] offset:17408
  ds_write_b128 v10, v[112:115] offset:18432
  ds_write_b128 v10, v[116:119] offset:19456
  s_waitcnt lgkmcnt(0)
  s_barrier
  ds_read_b128 v[128:131], v15 offset:0
  ds_read_b128 v[132:135], v15 offset:1024
  ds_read_b128 v[136:139], v15 offset:2048
  ds_read_b128 v[140:143], v15 offset:3072
  ds_read_b128 v[144:147], v3 offset:0
  ds_read_b128 v[148:151], v15 offset:20480
  ds_read_b128 v[152:155], v15 offset:21504
  ds_read_b128 v[156:159], v15 offset:22528
  ds_read_b128 v[160:163], v15 offset:23552
  ds_read_b128 v[164:167], v3 offset:20480
  ds_read_b128 v[168:171], v15 offset:40960
  ds_read_b128 v[172:175], v15 offset:41984
  ds_read_b128 v[176:179], v15 offset:43008
  ds_read_b128 v[180:183], v15 offset:44032
  ds_read_b128 v[184:187], v3 offset:40960
  ds_read_b128 v[188:191], v15 offset:61440
  ds_read_b128 v[192:195], v15 offset:62464
  ds_read_b128 v[196:199], v15 offset:63488
  ds_read_b128 v[200:203], v15 offset:64512
  ds_read_b128 v[204:207], v3 offset:61440
  v_lshlrev_b32 v32, 16, v232
  v_and_b32 v33, 0xffff0000, v232
  v_lshlrev_b32 v34, 16, v233
  v_and_b32 v35, 0xffff0000, v233
  v_lshlrev_b32 v36, 16, v234
  v_and_b32 v37, 0xffff0000, v234
  v_lshlrev_b32 v38, 16, v235
  v_and_b32 v39, 0xffff0000, v235
  v_lshlrev_b32 v40, 16, v236
  v_and_b32 v41, 0xffff0000, v236
  v_lshlrev_b32 v42, 16, v237
  v_and_b32 v43, 0xffff0000, v237
  v_lshlrev_b32 v44, 16, v238
  v_and_b32 v45, 0xffff0000, v238
  v_lshlrev_b32 v46, 16, v239
  v_and_b32 v47, 0xffff0000, v239
  v_lshlrev_b32 v48, 16, v240
  v_and_b32 v49, 0xffff0000, v240
  v_lshlrev_b32 v50, 16, v241
  v_and_b32 v51, 0xffff0000, v241
  s_waitcnt lgkmcnt(15)
  v_pk_add_f32 v[32:33], v[32:33], v[128:129]
  v_pk_add_f32 v[34:35], v[34:35], v[130:131]
  v_pk_add_f32 v[36:37], v[36:37], v[132:133]
  v_pk_add_f32 v[38:39], v[38:39], v[134:135]
  v_pk_add_f32 v[40:41], v[40:41], v[136:137]
  v_pk_add_f32 v[42:43], v[42:43], v[138:139]
  v_pk_add_f32 v[44:45], v[44:45], v[140:141]
  v_pk_add_f32 v[46:47], v[46:47], v[142:143]
  v_pk_add_f32 v[48:49], v[48:49], v[144:145]
  v_pk_add_f32 v[50:51], v[50:51], v[146:147]
  s_waitcnt lgkmcnt(10)
  v_pk_add_f32 v[32:33], v[32:33], v[148:149]
  v_pk_add_f32 v[34:35], v[34:35], v[150:151]
  v_pk_add_f32 v[36:37], v[36:37], v[152:153]
  v_pk_add_f32 v[38:39], v[38:39], v[154:155]
  v_pk_add_f32 v[40:41], v[40:41], v[156:157]
  v_pk_add_f32 v[42:43], v[42:43], v[158:159]
  v_pk_add_f32 v[44:45], v[44:45], v[160:161]
  v_pk_add_f32 v[46:47], v[46:47], v[162:163]
  v_pk_add_f32 v[48:49], v[48:49], v[164:165]
  v_pk_add_f32 v[50:51], v[50:51], v[166:167]
  s_waitcnt lgkmcnt(5)
  v_pk_add_f32 v[32:33], v[32:33], v[168:169]
  v_pk_add_f32 v[34:35], v[34:35], v[170:171]
  v_pk_add_f32 v[36:37], v[36:37], v[172:173]
  v_pk_add_f32 v[38:39], v[38:39], v[174:175]
  v_pk_add_f32 v[40:41], v[40:41], v[176:177]
  v_pk_add_f32 v[42:43], v[42:43], v[178:179]
  v_pk_add_f32 v[44:45], v[44:45], v[180:181]
  v_pk_add_f32 v[46:47], v[46:47], v[182:183]
  v_pk_add_f32 v[48:49], v[48:49], v[184:185]
  v_pk_add_f32 v[50:51], v[50:51], v[186:187]
  s_waitcnt lgkmcnt(0)
  v_pk_add_f32 v[32:33], v[32:33], v[188:189]
  v_pk_add_f32 v[34:35], v[34:35], v[190:191]
  v_pk_add_f32 v[36:37], v[36:37], v[192:193]
  v_pk_add_f32 v[38:39], v[38:39], v[194:195]
  v_pk_add_f32 v[40:41], v[40:41], v[196:197]
  v_pk_add_f32 v[42:43], v[42:43], v[198:199]
  v_pk_add_f32 v[44:45], v[44:45], v[200:201]
  v_pk_add_f32 v[46:47], v[46:47], v[202:203]
  v_pk_add_f32 v[48:49], v[48:49], v[204:205]
  v_pk_add_f32 v[50:51], v[50:51], v[206:207]
  v_cvt_pk_bf16_f32 v232, v32, v33
  v_cvt_pk_bf16_f32 v233, v34, v35
  v_cvt_pk_bf16_f32 v234, v36, v37
  v_cvt_pk_bf16_f32 v235, v38, v39
  v_cvt_pk_bf16_f32 v236, v40, v41
  v_cvt_pk_bf16_f32 v237, v42, v43
  v_cvt_pk_bf16_f32 v238, v44, v45
  v_cvt_pk_bf16_f32 v239, v46, v47
  v_cvt_pk_bf16_f32 v240, v48, v49
  v_cvt_pk_bf16_f32 v241, v50, v51
  buffer_store_dwordx4 v[232:235], v12, s[36:39], s43 offen
  buffer_store_dwordx4 v[236:239], v12, s[36:39], s43 offen offset:16
  buffer_store_dwordx2 v[240:241], v13, s[36:39], s43 offen
  s_endpgm
.p2align 6
parallel_sum__grouped_kv_mqa__swiglu_ffn__prompt_kernel_roleA1:
  s_load_dword s72, s[70:71], 0
  s_mov_b32 s44, s70
  s_mov_b32 s45, s71
  s_mov_b32 s46, 0xe98000
  s_mov_b32 s47, 0x20000
  s_mov_b32 s74, 200000
  s_add_u32 m0, s14, 20480
  s_add_u32 s24, s70, 0x20000
  s_addc_u32 s25, s71, 0
  s_mov_b32 s26, 0x30000
  s_mov_b32 s27, 0x20000
  s_add_u32 s28, s70, 0x300000
  s_addc_u32 s29, s71, 0
  buffer_load_dwordx4 v16, s[20:23], s34 offen lds
  s_add_u32 m0, m0, 1024
  s_mov_b32 s30, 0x880000
  s_mov_b32 s31, 0x20000
  v_lshrrev_b32 v6, 5, v1
  v_bfe_u32 v7, v1, 2, 2
  v_lshl_add_u32 v7, v6, 2, v7
  v_mul_u32_u24 v4, 320, v7
  buffer_load_dwordx4 v17, s[20:23], s34 offen lds
  s_add_u32 m0, m0, 1024
  v_and_b32 v7, 1, v1
  v_lshlrev_b32 v7, 4, v7
  v_bfe_u32 v8, v1, 1, 1
  v_lshl_add_u32 v7, v8, 3, v7
  v_and_b32 v8, 16, v1
  v_cmp_ne_u32 vcc, 0, v8
  buffer_load_dwordx4 v18, s[20:23], s34 offen lds
  s_add_u32 m0, m0, 1024
  v_mov_b32 v8, 32
  v_cndmask_b32 v7, v7, v8, vcc
  v_add_u32 v4, v4, v7
  s_mul_i32 s32, s3, 40
  v_add_u32 v4, s32, v4
  v_and_b32 v8, 19, v1
  buffer_load_dwordx4 v19, s[20:23], s34 offen lds
  s_add_u32 m0, m0, 1024
  v_cmp_lt_u32 vcc, 16, v8
  v_mov_b32 v8, 0x40000
  s_nop 0
  v_cndmask_b32 v4, v4, v8, vcc
  v_add_u32 v5, 40960, v4
  v_and_b32 v7, 31, v1
  v_bfe_u32 v8, v1, 1, 3
  s_mov_b64 exec, s[18:19]
  buffer_load_dwordx4 v20, s[20:23], s34 offen lds
  s_mov_b64 exec, -1
  s_add_u32 s34, s34, s13
  s_cmp_eq_u32 s34, s35
  s_cselect_b32 s34, s12, s34
  v_lshrrev_b32 v9, 5, v1
  v_xor_b32 v8, v8, v9
  v_lshlrev_b32 v7, 7, v7
  v_lshl_add_u32 v7, v8, 4, v7
  v_xor_b32 v8, 0, v7
  v_add_u32 v24, 10240, v8
  s_add_u32 m0, s14, 40960
  v_xor_b32 v8, 32, v7
  v_add_u32 v25, 10240, v8
  v_xor_b32 v8, 64, v7
  v_add_u32 v26, 10240, v8
  v_xor_b32 v8, 96, v7
  v_add_u32 v27, 10240, v8
  buffer_load_dwordx4 v16, s[20:23], s34 offen lds
  s_add_u32 m0, m0, 1024
  v_mov_b32 v28, 0x3f803f80
  v_mov_b32 v29, 0x3f803f80
  v_mov_b32 v30, 0x3f803f80
  v_mov_b32 v31, 0x3f803f80
  v_add_u32 v224, 40960, v24
  v_add_u32 v225, 40960, v25
  buffer_load_dwordx4 v17, s[20:23], s34 offen lds
  s_add_u32 m0, m0, 1024
  v_add_u32 v226, 40960, v26
  v_add_u32 v227, 40960, v27
  v_and_b32 v7, 31, v1
  v_lshlrev_b32 v11, 3, v7
  v_add_u32 v11, 1024, v11
  v_lshl_add_u32 v11, v6, 18, v11
  buffer_load_dwordx4 v18, s[20:23], s34 offen lds
  s_add_u32 m0, m0, 1024
  v_and_b32 v13, 19, v7
  v_bfe_u32 v14, v7, 2, 1
  v_lshl_add_u32 v13, v14, 3, v13
  v_bfe_u32 v14, v7, 3, 1
  v_lshl_add_u32 v13, v14, 2, v13
  v_mul_u32_u24 v12, 24, v6
  buffer_load_dwordx4 v19, s[20:23], s34 offen lds
  s_add_u32 m0, m0, 1024
  v_add_u32 v12, v12, v13
  v_cmp_le_u32 vcc, 28, v7
  s_nop 1
  v_cndmask_b32 v13, 0, 1, vcc
  v_xor_b32 v13, v13, v6
  v_mul_u32_u24 v13, 24, v13
  v_add_u32 v13, 20, v13
  s_mov_b64 exec, s[18:19]
  buffer_load_dwordx4 v20, s[20:23], s34 offen lds
  s_mov_b64 exec, -1
  s_add_u32 s34, s34, s13
  s_cmp_eq_u32 s34, s35
  s_cselect_b32 s34, s12, s34
  v_and_b32 v15, 27, v7
  v_cmp_ne_u32 vcc, 24, v15
  v_mov_b32 v15, 0x4000
  s_nop 0
  v_cndmask_b32 v13, v13, v15, vcc
  v_cmp_le_u32 vcc, 20, v7
  s_nop 1
  v_cndmask_b32 v12, v12, v13, vcc
  s_add_u32 m0, s14, 61440
  v_lshlrev_b32 v12, 4, v12
  v_add_u32 v12, 1536, v12
  v_add_u32 v8, 57344, v2
  v_add_u32 v9, 57344, v11
  v_add_u32 v10, 57344, v12
  s_lshr_b32 s32, s3, 1
  buffer_load_dwordx4 v16, s[20:23], s34 offen lds
  s_add_u32 m0, m0, 1024
  s_lshl_b32 s32, s32, 9
  s_and_b32 s33, s3, 1
  s_lshl_b32 s33, s33, 3
  s_add_u32 s32, s32, s33
  v_lshl_add_u32 v241, v7, 4, s32
  v_lshl_add_u32 v241, v6, 30, v241
  buffer_load_dwordx4 v17, s[20:23], s34 offen lds
  s_add_u32 m0, m0, 1024
  v_lshlrev_b32 v13, 2, v1
  v_lshlrev_b32 v14, 3, v7
  s_lshl_b32 s39, s8, 9
  s_add_u32 s39, s39, 4096
  s_lshl_b32 s38, s3, 8
  s_add_u32 s38, s38, 15204352
  buffer_load_dwordx4 v18, s[20:23], s34 offen lds
  s_add_u32 m0, m0, 1024
  s_mul_i32 s36, s3, 6144
  v_mov_b32 v182, 0
  v_mov_b32 v183, 0
  v_mov_b32 v190, 0
  v_mov_b32 v191, 0
  v_mov_b32 v198, 0
  buffer_load_dwordx4 v19, s[20:23], s34 offen lds
  s_add_u32 m0, m0, 1024
  v_mov_b32 v199, 0
  v_mov_b32 v206, 0
  v_mov_b32 v207, 0
  s_mov_b64 exec, s[18:19]
  buffer_load_dwordx4 v20, s[20:23], s34 offen lds
  s_mov_b64 exec, -1
  s_add_u32 s34, s34, s13
  s_cmp_eq_u32 s34, s35
  s_cselect_b32 s34, s12, s34
  s_waitcnt lgkmcnt(0)
  s_mul_i32 s73, s72, 1664525
  s_add_u32 s73, s73, 1013904223
  s_waitcnt vmcnt(15)
  s_barrier
  ds_read_b64_tr_b16 v[80:81], v4 offset:0
  ds_read_b64_tr_b16 v[82:83], v4 offset:160
  ds_read_b128 v[84:87], v24 offset:0
  ds_read_b128 v[88:91], v24 offset:5120
  ds_read_b64_tr_b16 v[92:93], v4 offset:2560
  ds_read_b64_tr_b16 v[94:95], v4 offset:2720
  ds_read_b128 v[96:99], v25 offset:0
  ds_read_b128 v[100:103], v25 offset:5120
  ds_read_b64_tr_b16 v[104:105], v4 offset:5120
  ds_read_b64_tr_b16 v[106:107], v4 offset:5280
  ds_read_b128 v[108:111], v26 offset:0
  ds_read_b128 v[112:115], v26 offset:5120
  ds_read_b64_tr_b16 v[116:117], v4 offset:7680
  ds_read_b64_tr_b16 v[118:119], v4 offset:7840
  ds_read_b128 v[120:123], v27 offset:0
  ds_read_b128 v[124:127], v27 offset:5120
  s_waitcnt vmcnt(10) lgkmcnt(0)
  s_barrier
  v_mfma_f32_32x32x16_bf16 v[32:47], v[80:83], v[84:87], 0
  ds_read_b64_tr_b16 v[128:129], v4 offset:20480
  ds_read_b64_tr_b16 v[130:131], v4 offset:20640
  s_add_u32 m0, s14, 0
  v_mfma_f32_32x32x16_bf16 v[48:63], v[80:83], v[88:91], 0
  ds_read_b128 v[132:135], v24 offset:20480
  ds_read_b128 v[136:139], v24 offset:25600
  buffer_load_dwordx4 v16, s[20:23], s34 offen lds
  s_add_u32 m0, m0, 1024
  v_mfma_f32_32x32x16_bf16 v[64:79], v[80:83], v[28:31], 0
  ds_read_b64_tr_b16 v[140:141], v4 offset:23040
  ds_read_b64_tr_b16 v[142:143], v4 offset:23200
  buffer_load_dwordx4 v17, s[20:23], s34 offen lds
  s_add_u32 m0, m0, 1024
  v_mfma_f32_32x32x16_bf16 v[32:47], v[92:95], v[96:99], v[32:47]
  ds_read_b128 v[144:147], v25 offset:20480
  ds_read_b128 v[148:151], v25 offset:25600
  buffer_load_dwordx4 v18, s[20:23], s34 offen lds
  s_add_u32 m0, m0, 1024
  v_mfma_f32_32x32x16_bf16 v[48:63], v[92:95], v[100:103], v[48:63]
  ds_read_b64_tr_b16 v[152:153], v4 offset:25600
  ds_read_b64_tr_b16 v[154:155], v4 offset:25760
  buffer_load_dwordx4 v19, s[20:23], s34 offen lds
  s_add_u32 m0, m0, 1024
  v_mfma_f32_32x32x16_bf16 v[64:79], v[92:95], v[28:31], v[64:79]
  ds_read_b128 v[156:159], v26 offset:20480
  ds_read_b128 v[160:163], v26 offset:25600
  s_mov_b64 exec, s[18:19]
  buffer_load_dwordx4 v20, s[20:23], s34 offen lds
  s_mov_b64 exec, -1
  s_add_u32 s34, s34, s13
  s_cmp_eq_u32 s34, s35
  s_cselect_b32 s34, s12, s34
  v_mfma_f32_32x32x16_bf16 v[32:47], v[104:107], v[108:111], v[32:47]
  ds_read_b64_tr_b16 v[164:165], v4 offset:28160
  ds_read_b64_tr_b16 v[166:167], v4 offset:28320
  v_mfma_f32_32x32x16_bf16 v[48:63], v[104:107], v[112:115], v[48:63]
  ds_read_b128 v[168:171], v27 offset:20480
  ds_read_b128 v[172:175], v27 offset:25600
  v_mfma_f32_32x32x16_bf16 v[64:79], v[104:107], v[28:31], v[64:79]
  v_mfma_f32_32x32x16_bf16 v[32:47], v[116:119], v[120:123], v[32:47]
  v_mfma_f32_32x32x16_bf16 v[48:63], v[116:119], v[124:127], v[48:63]
  v_mfma_f32_32x32x16_bf16 v[64:79], v[116:119], v[28:31], v[64:79]
  s_waitcnt vmcnt(10) lgkmcnt(0)
  s_barrier
  v_mfma_f32_32x32x16_bf16 v[32:47], v[128:131], v[132:135], v[32:47]
  ds_read_b64_tr_b16 v[80:81], v5 offset:0
  ds_read_b64_tr_b16 v[82:83], v5 offset:160
  s_add_u32 m0, s14, 20480
  v_mfma_f32_32x32x16_bf16 v[48:63], v[128:131], v[136:139], v[48:63]
  ds_read_b128 v[84:87], v224 offset:0
  ds_read_b128 v[88:91], v224 offset:5120
  buffer_load_dwordx4 v16, s[20:23], s34 offen lds
  s_add_u32 m0, m0, 1024
  v_mfma_f32_32x32x16_bf16 v[64:79], v[128:131], v[28:31], v[64:79]
  ds_read_b64_tr_b16 v[92:93], v5 offset:2560
  ds_read_b64_tr_b16 v[94:95], v5 offset:2720
  buffer_load_dwordx4 v17, s[20:23], s34 offen lds
  s_add_u32 m0, m0, 1024
  v_mfma_f32_32x32x16_bf16 v[32:47], v[140:143], v[144:147], v[32:47]
  ds_read_b128 v[96:99], v225 offset:0
  ds_read_b128 v[100:103], v225 offset:5120
  buffer_load_dwordx4 v18, s[20:23], s34 offen lds
  s_add_u32 m0, m0, 1024
  v_mfma_f32_32x32x16_bf16 v[48:63], v[140:143], v[148:151], v[48:63]
  ds_read_b64_tr_b16 v[104:105], v5 offset:5120
  ds_read_b64_tr_b16 v[106:107], v5 offset:5280
  buffer_load_dwordx4 v19, s[20:23], s34 offen lds
  s_add_u32 m0, m0, 1024
  v_mfma_f32_32x32x16_bf16 v[64:79], v[140:143], v[28:31], v[64:79]
  ds_read_b128 v[108:111], v226 offset:0
  ds_read_b128 v[112:115], v226 offset:5120
  s_mov_b64 exec, s[18:19]
  buffer_load_dwordx4 v20, s[20:23], s34 offen lds
  s_mov_b64 exec, -1
  s_add_u32 s34, s34, s13
  s_cmp_eq_u32 s34, s35
  s_cselect_b32 s34, s12, s34
  v_mfma_f32_32x32x16_bf16 v[32:47], v[152:155], v[156:159], v[32:47]
  ds_read_b64_tr_b16 v[116:117], v5 offset:7680
  ds_read_b64_tr_b16 v[118:119], v5 offset:7840
  v_mfma_f32_32x32x16_bf16 v[48:63], v[152:155], v[160:163], v[48:63]
  ds_read_b128 v[120:123], v227 offset:0
  ds_read_b128 v[124:127], v227 offset:5120
  v_mfma_f32_32x32x16_bf16 v[64:79], v[152:155], v[28:31], v[64:79]
  v_mfma_f32_32x32x16_bf16 v[32:47], v[164:167], v[168:171], v[32:47]
  v_mfma_f32_32x32x16_bf16 v[48:63], v[164:167], v[172:175], v[48:63]
  v_mfma_f32_32x32x16_bf16 v[64:79], v[164:167], v[28:31], v[64:79]
  s_waitcnt vmcnt(10) lgkmcnt(0)
  s_barrier
  v_mfma_f32_32x32x16_bf16 v[32:47], v[80:83], v[84:87], v[32:47]
  ds_read_b64_tr_b16 v[128:129], v5 offset:20480
  ds_read_b64_tr_b16 v[130:131], v5 offset:20640
  s_add_u32 m0, s14, 40960
  v_mfma_f32_32x32x16_bf16 v[48:63], v[80:83], v[88:91], v[48:63]
  ds_read_b128 v[132:135], v224 offset:20480
  ds_read_b128 v[136:139], v224 offset:25600
  buffer_load_dwordx4 v16, s[20:23], s34 offen lds
  s_add_u32 m0, m0, 1024
  v_mfma_f32_32x32x16_bf16 v[64:79], v[80:83], v[28:31], v[64:79]
  ds_read_b64_tr_b16 v[140:141], v5 offset:23040
  ds_read_b64_tr_b16 v[142:143], v5 offset:23200
  buffer_load_dwordx4 v17, s[20:23], s34 offen lds
  s_add_u32 m0, m0, 1024
  v_mfma_f32_32x32x16_bf16 v[32:47], v[92:95], v[96:99], v[32:47]
  ds_read_b128 v[144:147], v225 offset:20480
  ds_read_b128 v[148:151], v225 offset:25600
  buffer_load_dwordx4 v18, s[20:23], s34 offen lds
  s_add_u32 m0, m0, 1024
  v_mfma_f32_32x32x16_bf16 v[48:63], v[92:95], v[100:103], v[48:63]
  ds_read_b64_tr_b16 v[152:153], v5 offset:25600
  ds_read_b64_tr_b16 v[154:155], v5 offset:25760
  buffer_load_dwordx4 v19, s[20:23], s34 offen lds
  s_add_u32 m0, m0, 1024
  v_mfma_f32_32x32x16_bf16 v[64:79], v[92:95], v[28:31], v[64:79]
  ds_read_b128 v[156:159], v226 offset:20480
  ds_read_b128 v[160:163], v226 offset:25600
  s_mov_b64 exec, s[18:19]
  buffer_load_dwordx4 v20, s[20:23], s34 offen lds
  s_mov_b64 exec, -1
  s_add_u32 s34, s34, s13
  s_cmp_eq_u32 s34, s35
  s_cselect_b32 s34, s12, s34
  v_mfma_f32_32x32x16_bf16 v[32:47], v[104:107], v[108:111], v[32:47]
  ds_read_b64_tr_b16 v[164:165], v5 offset:28160
  ds_read_b64_tr_b16 v[166:167], v5 offset:28320
  v_mfma_f32_32x32x16_bf16 v[48:63], v[104:107], v[112:115], v[48:63]
  ds_read_b128 v[168:171], v227 offset:20480
  ds_read_b128 v[172:175], v227 offset:25600
  v_mfma_f32_32x32x16_bf16 v[64:79], v[104:107], v[28:31], v[64:79]
  v_mfma_f32_32x32x16_bf16 v[32:47], v[116:119], v[120:123], v[32:47]
  v_mfma_f32_32x32x16_bf16 v[48:63], v[116:119], v[124:127], v[48:63]
  v_mfma_f32_32x32x16_bf16 v[64:79], v[116:119], v[28:31], v[64:79]
  s_waitcnt vmcnt(10) lgkmcnt(0)
  s_barrier
  v_mfma_f32_32x32x16_bf16 v[32:47], v[128:131], v[132:135], v[32:47]
  ds_read_b64_tr_b16 v[80:81], v4 offset:0
  ds_read_b64_tr_b16 v[82:83], v4 offset:160
  s_add_u32 m0, s14, 61440
  v_mfma_f32_32x32x16_bf16 v[48:63], v[128:131], v[136:139], v[48:63]
  ds_read_b128 v[84:87], v24 offset:0
  ds_read_b128 v[88:91], v24 offset:5120
  buffer_load_dwordx4 v16, s[20:23], s34 offen lds
  s_add_u32 m0, m0, 1024
  v_mfma_f32_32x32x16_bf16 v[64:79], v[128:131], v[28:31], v[64:79]
  ds_read_b64_tr_b16 v[92:93], v4 offset:2560
  ds_read_b64_tr_b16 v[94:95], v4 offset:2720
  buffer_load_dwordx4 v17, s[20:23], s34 offen lds
  s_add_u32 m0, m0, 1024
  v_mfma_f32_32x32x16_bf16 v[32:47], v[140:143], v[144:147], v[32:47]
  ds_read_b128 v[96:99], v25 offset:0
  ds_read_b128 v[100:103], v25 offset:5120
  buffer_load_dwordx4 v18, s[20:23], s34 offen lds
  s_add_u32 m0, m0, 1024
  v_mfma_f32_32x32x16_bf16 v[48:63], v[140:143], v[148:151], v[48:63]
  ds_read_b64_tr_b16 v[104:105], v4 offset:5120
  ds_read_b64_tr_b16 v[106:107], v4 offset:5280
  buffer_load_dwordx4 v19, s[20:23], s34 offen lds
  s_add_u32 m0, m0, 1024
  v_mfma_f32_32x32x16_bf16 v[64:79], v[140:143], v[28:31], v[64:79]
  ds_read_b128 v[108:111], v26 offset:0
  ds_read_b128 v[112:115], v26 offset:5120
  s_mov_b64 exec, s[18:19]
  buffer_load_dwordx4 v20, s[20:23], s34 offen lds
  s_mov_b64 exec, -1
  s_add_u32 s34, s34, s13
  s_cmp_eq_u32 s34, s35
  s_cselect_b32 s34, s12, s34
  v_mfma_f32_32x32x16_bf16 v[32:47], v[152:155], v[156:159], v[32:47]
  ds_read_b64_tr_b16 v[116:117], v4 offset:7680
  ds_read_b64_tr_b16 v[118:119], v4 offset:7840
  v_mfma_f32_32x32x16_bf16 v[48:63], v[152:155], v[160:163], v[48:63]
  ds_read_b128 v[120:123], v27 offset:0
  ds_read_b128 v[124:127], v27 offset:5120
  v_mfma_f32_32x32x16_bf16 v[64:79], v[152:155], v[28:31], v[64:79]
  v_mfma_f32_32x32x16_bf16 v[32:47], v[164:167], v[168:171], v[32:47]
  v_mfma_f32_32x32x16_bf16 v[48:63], v[164:167], v[172:175], v[48:63]
  v_mfma_f32_32x32x16_bf16 v[64:79], v[164:167], v[28:31], v[64:79]
  s_waitcnt vmcnt(10) lgkmcnt(0)
  s_barrier
  s_lshl_b32 s37, s2, 7
  s_add_u32 s37, s37, 15269888
  s_cmp_lg_u32 s3, 0
  s_cbranch_scc1 parallel_sum__grouped_kv_mqa__swiglu_ffn__prompt_kernel_nofl49
  v_mov_b32 v242, s73
  v_mov_b32 v243, 0
  s_mov_b64 exec, 1
  buffer_store_dword v242, v243, s[44:47], s37 offen sc1
  s_mov_b64 exec, -1
parallel_sum__grouped_kv_mqa__swiglu_ffn__prompt_kernel_nofl49:
  v_mfma_f32_32x32x16_bf16 v[32:47], v[80:83], v[84:87], v[32:47]
  ds_read_b64_tr_b16 v[128:129], v4 offset:20480
  ds_read_b64_tr_b16 v[130:131], v4 offset:20640
  s_add_u32 m0, s14, 0
  v_mfma_f32_32x32x16_bf16 v[48:63], v[80:83], v[88:91], v[48:63]
  ds_read_b128 v[132:135], v24 offset:20480
  ds_read_b128 v[136:139], v24 offset:25600
  buffer_load_dwordx4 v16, s[20:23], s34 offen lds
  s_add_u32 m0, m0, 1024
  v_mfma_f32_32x32x16_bf16 v[64:79], v[80:83], v[28:31], v[64:79]
  ds_read_b64_tr_b16 v[140:141], v4 offset:23040
  ds_read_b64_tr_b16 v[142:143], v4 offset:23200
  buffer_load_dwordx4 v17, s[20:23], s34 offen lds
  s_add_u32 m0, m0, 1024
  v_mfma_f32_32x32x16_bf16 v[32:47], v[92:95], v[96:99], v[32:47]
  ds_read_b128 v[144:147], v25 offset:20480
  ds_read_b128 v[148:151], v25 offset:25600
  buffer_load_dwordx4 v18, s[20:23], s34 offen lds
  s_add_u32 m0, m0, 1024
  v_mfma_f32_32x32x16_bf16 v[48:63], v[92:95], v[100:103], v[48:63]
  ds_read_b64_tr_b16 v[152:153], v4 offset:25600
  ds_read_b64_tr_b16 v[154:155], v4 offset:25760
  buffer_load_dwordx4 v19, s[20:23], s34 offen lds
  s_add_u32 m0, m0, 1024
  v_mfma_f32_32x32x16_bf16 v[64:79], v[92:95], v[28:31], v[64:79]
  ds_read_b128 v[156:159], v26 offset:20480
  ds_read_b128 v[160:163], v26 offset:25600
  s_mov_b64 exec, s[18:19]
  buffer_load_dwordx4 v20, s[20:23], s34 offen lds
  s_mov_b64 exec, -1
  s_add_u32 s34, s34, s13
  s_cmp_eq_u32 s34, s35
  s_cselect_b32 s34, s12, s34
  v_mfma_f32_32x32x16_bf16 v[32:47], v[104:107], v[108:111], v[32:47]
  ds_read_b64_tr_b16 v[164:165], v4 offset:28160
  ds_read_b64_tr_b16 v[166:167], v4 offset:28320
  v_mfma_f32_32x32x16_bf16 v[48:63], v[104:107], v[112:115], v[48:63]
  ds_read_b128 v[168:171], v27 offset:20480
  ds_read_b128 v[172:175], v27 offset:25600
  v_mfma_f32_32x32x16_bf16 v[64:79], v[104:107], v[28:31], v[64:79]
  v_mfma_f32_32x32x16_bf16 v[32:47], v[116:119], v[120:123], v[32:47]
  v_mfma_f32_32x32x16_bf16 v[48:63], v[116:119], v[124:127], v[48:63]
  v_mfma_f32_32x32x16_bf16 v[64:79], v[116:119], v[28:31], v[64:79]
  s_waitcnt vmcnt(10) lgkmcnt(0)
  s_barrier
  v_mfma_f32_32x32x16_bf16 v[32:47], v[128:131], v[132:135], v[32:47]
  ds_read_b64_tr_b16 v[80:81], v5 offset:0
  ds_read_b64_tr_b16 v[82:83], v5 offset:160
  s_add_u32 m0, s14, 20480
  v_mfma_f32_32x32x16_bf16 v[48:63], v[128:131], v[136:139], v[48:63]
  ds_read_b128 v[84:87], v224 offset:0
  ds_read_b128 v[88:91], v224 offset:5120
  buffer_load_dwordx4 v16, s[20:23], s34 offen lds
  s_add_u32 m0, m0, 1024
  v_mfma_f32_32x32x16_bf16 v[64:79], v[128:131], v[28:31], v[64:79]
  ds_read_b64_tr_b16 v[92:93], v5 offset:2560
  ds_read_b64_tr_b16 v[94:95], v5 offset:2720
  buffer_load_dwordx4 v17, s[20:23], s34 offen lds
  s_add_u32 m0, m0, 1024
  v_mfma_f32_32x32x16_bf16 v[32:47], v[140:143], v[144:147], v[32:47]
  ds_read_b128 v[96:99], v225 offset:0
  ds_read_b128 v[100:103], v225 offset:5120
  buffer_load_dwordx4 v18, s[20:23], s34 offen lds
  s_add_u32 m0, m0, 1024
  v_mfma_f32_32x32x16_bf16 v[48:63], v[140:143], v[148:151], v[48:63]
  ds_read_b64_tr_b16 v[104:105], v5 offset:5120
  ds_read_b64_tr_b16 v[106:107], v5 offset:5280
  buffer_load_dwordx4 v19, s[20:23], s34 offen lds
  s_add_u32 m0, m0, 1024
  v_mfma_f32_32x32x16_bf16 v[64:79], v[140:143], v[28:31], v[64:79]
  ds_read_b128 v[108:111], v226 offset:0
  ds_read_b128 v[112:115], v226 offset:5120
  s_mov_b64 exec, s[18:19]
  buffer_load_dwordx4 v20, s[20:23], s34 offen lds
  s_mov_b64 exec, -1
  s_add_u32 s34, s34, s13
  s_cmp_eq_u32 s34, s35
  s_cselect_b32 s34, s12, s34
  v_mfma_f32_32x32x16_bf16 v[32:47], v[152:155], v[156:159], v[32:47]
  ds_read_b64_tr_b16 v[116:117], v5 offset:7680
  ds_read_b64_tr_b16 v[118:119], v5 offset:7840
  buffer_load_dwordx2 v[234:235], v14, s[44:47], s39 offen sc1
  buffer_load_dwordx2 v[236:237], v14, s[44:47], s39 offen offset:256 sc1
  buffer_load_dword v232, v13, s[44:47], s38 offen sc1
  v_mfma_f32_32x32x16_bf16 v[48:63], v[152:155], v[160:163], v[48:63]
  ds_read_b128 v[120:123], v227 offset:0
  ds_read_b128 v[124:127], v227 offset:5120
  v_mfma_f32_32x32x16_bf16 v[64:79], v[152:155], v[28:31], v[64:79]
  v_mfma_f32_32x32x16_bf16 v[32:47], v[164:167], v[168:171], v[32:47]
  v_mfma_f32_32x32x16_bf16 v[48:63], v[164:167], v[172:175], v[48:63]
  v_mfma_f32_32x32x16_bf16 v[64:79], v[164:167], v[28:31], v[64:79]
  s_waitcnt vmcnt(13) lgkmcnt(0)
  s_barrier
  v_mfma_f32_32x32x16_bf16 v[32:47], v[80:83], v[84:87], v[32:47]
  ds_read_b64_tr_b16 v[128:129], v5 offset:20480
  ds_read_b64_tr_b16 v[130:131], v5 offset:20640
  v_mfma_f32_32x32x16_bf16 v[48:63], v[80:83], v[88:91], v[48:63]
  ds_read_b128 v[132:135], v224 offset:20480
  ds_read_b128 v[136:139], v224 offset:25600
  v_mfma_f32_32x32x16_bf16 v[64:79], v[80:83], v[28:31], v[64:79]
  ds_read_b64_tr_b16 v[140:141], v5 offset:23040
  ds_read_b64_tr_b16 v[142:143], v5 offset:23200
  v_mfma_f32_32x32x16_bf16 v[32:47], v[92:95], v[96:99], v[32:47]
  ds_read_b128 v[144:147], v225 offset:20480
  ds_read_b128 v[148:151], v225 offset:25600
  v_mfma_f32_32x32x16_bf16 v[48:63], v[92:95], v[100:103], v[48:63]
  ds_read_b64_tr_b16 v[152:153], v5 offset:25600
  ds_read_b64_tr_b16 v[154:155], v5 offset:25760
  v_mfma_f32_32x32x16_bf16 v[64:79], v[92:95], v[28:31], v[64:79]
  ds_read_b128 v[156:159], v226 offset:20480
  ds_read_b128 v[160:163], v226 offset:25600
  v_mfma_f32_32x32x16_bf16 v[32:47], v[104:107], v[108:111], v[32:47]
  ds_read_b64_tr_b16 v[164:165], v5 offset:28160
  ds_read_b64_tr_b16 v[166:167], v5 offset:28320
  v_mfma_f32_32x32x16_bf16 v[48:63], v[104:107], v[112:115], v[48:63]
  ds_read_b128 v[168:171], v227 offset:20480
  ds_read_b128 v[172:175], v227 offset:25600
  v_mfma_f32_32x32x16_bf16 v[64:79], v[104:107], v[28:31], v[64:79]
  v_mfma_f32_32x32x16_bf16 v[32:47], v[116:119], v[120:123], v[32:47]
  v_mfma_f32_32x32x16_bf16 v[48:63], v[116:119], v[124:127], v[48:63]
  v_mfma_f32_32x32x16_bf16 v[64:79], v[116:119], v[28:31], v[64:79]
  s_branch parallel_sum__grouped_kv_mqa__swiglu_ffn__prompt_kernel_pchk52
parallel_sum__grouped_kv_mqa__swiglu_ffn__prompt_kernel_poll50:
  buffer_load_dwordx2 v[234:235], v14, s[44:47], s39 offen sc1
  buffer_load_dwordx2 v[236:237], v14, s[44:47], s39 offen offset:256 sc1
  buffer_load_dword v232, v13, s[44:47], s38 offen sc1
parallel_sum__grouped_kv_mqa__swiglu_ffn__prompt_kernel_pchk52:
  s_waitcnt vmcnt(0)
  v_xor_b32 v15, s73, v232
  v_xor_b32 v235, s73, v235
  v_or_b32 v15, v15, v235
  v_xor_b32 v237, s73, v237
  v_or_b32 v15, v15, v237
  v_cmp_ne_u32 vcc, 0, v15
  s_nop 0
  s_cmp_eq_u64 vcc, 0
  s_cbranch_scc1 parallel_sum__grouped_kv_mqa__swiglu_ffn__prompt_kernel_pdone51
  s_cmp_eq_u32 s74, 0
  s_cbranch_scc1 parallel_sum__grouped_kv_mqa__swiglu_ffn__prompt_kernel_pdone51
  s_sub_u32 s74, s74, 1
  s_sleep 4
  s_branch parallel_sum__grouped_kv_mqa__swiglu_ffn__prompt_kernel_poll50
parallel_sum__grouped_kv_mqa__swiglu_ffn__prompt_kernel_pdone51:
  s_waitcnt lgkmcnt(0)
  s_barrier
  v_mfma_f32_32x32x16_bf16 v[32:47], v[128:131], v[132:135], v[32:47]
  ds_read_b64_tr_b16 v[80:81], v4 offset:0
  ds_read_b64_tr_b16 v[82:83], v4 offset:160
  s_add_u32 m0, s36, 57344
  s_add_u32 s32, s36, 0
  v_mfma_f32_32x32x16_bf16 v[48:63], v[128:131], v[136:139], v[48:63]
  ds_read_b128 v[84:87], v24 offset:0
  ds_read_b128 v[88:91], v24 offset:5120
  buffer_load_dwordx4 v2, s[24:27], s32 offen offset:0 sc1 lds
  v_mfma_f32_32x32x16_bf16 v[64:79], v[128:131], v[28:31], v[64:79]
  ds_read_b64_tr_b16 v[92:93], v4 offset:2560
  ds_read_b64_tr_b16 v[94:95], v4 offset:2720
  buffer_load_dwordx4 v2, s[24:27], s32 offen offset:1024 sc1 lds
  v_mfma_f32_32x32x16_bf16 v[32:47], v[140:143], v[144:147], v[32:47]
  ds_read_b128 v[96:99], v25 offset:0
  ds_read_b128 v[100:103], v25 offset:5120
  buffer_load_dwordx4 v2, s[24:27], s32 offen offset:2048 sc1 lds
  v_mfma_f32_32x32x16_bf16 v[48:63], v[140:143], v[148:151], v[48:63]
  ds_read_b64_tr_b16 v[104:105], v4 offset:5120
  ds_read_b64_tr_b16 v[106:107], v4 offset:5280
  s_add_u32 m0, s36, 60416
  s_add_u32 s32, s36, 3072
  v_mfma_f32_32x32x16_bf16 v[64:79], v[140:143], v[28:31], v[64:79]
  ds_read_b128 v[108:111], v26 offset:0
  ds_read_b128 v[112:115], v26 offset:5120
  buffer_load_dwordx4 v2, s[24:27], s32 offen offset:0 sc1 lds
  v_mfma_f32_32x32x16_bf16 v[32:47], v[152:155], v[156:159], v[32:47]
  ds_read_b64_tr_b16 v[116:117], v4 offset:7680
  ds_read_b64_tr_b16 v[118:119], v4 offset:7840
  buffer_load_dwordx4 v2, s[24:27], s32 offen offset:1024 sc1 lds
  v_mfma_f32_32x32x16_bf16 v[48:63], v[152:155], v[160:163], v[48:63]
  ds_read_b128 v[120:123], v27 offset:0
  ds_read_b128 v[124:127], v27 offset:5120
  buffer_load_dwordx4 v2, s[24:27], s32 offen offset:2048 sc1 lds
  v_mfma_f32_32x32x16_bf16 v[64:79], v[152:155], v[28:31], v[64:79]
  v_mfma_f32_32x32x16_bf16 v[32:47], v[164:167], v[168:171], v[32:47]
  v_mfma_f32_32x32x16_bf16 v[48:63], v[164:167], v[172:175], v[48:63]
  v_mfma_f32_32x32x16_bf16 v[64:79], v[164:167], v[28:31], v[64:79]
  s_waitcnt lgkmcnt(0)
  s_barrier
  v_mfma_f32_32x32x16_bf16 v[32:47], v[80:83], v[84:87], v[32:47]
  ds_read_b64_tr_b16 v[128:129], v4 offset:20480
  ds_read_b64_tr_b16 v[130:131], v4 offset:20640
  v_lshlrev_b32 v238, 16, v234
  v_xor_b32 v238, 0x80000000, v238
  v_and_b32 v234, 0xffff0000, v234
  v_mfma_f32_32x32x16_bf16 v[48:63], v[80:83], v[88:91], v[48:63]
  ds_read_b128 v[132:135], v24 offset:20480
  ds_read_b128 v[136:139], v24 offset:25600
  v_rcp_f32 v234, v234
  s_nop 0
  v_mul_f32 v234, 0x3e64f92e, v234
  v_lshlrev_b32 v239, 16, v236
  v_mfma_f32_32x32x16_bf16 v[64:79], v[80:83], v[28:31], v[64:79]
  ds_read_b64_tr_b16 v[140:141], v4 offset:23040
  ds_read_b64_tr_b16 v[142:143], v4 offset:23200
  v_xor_b32 v239, 0x80000000, v239
  v_and_b32 v236, 0xffff0000, v236
  v_rcp_f32 v236, v236
  v_mfma_f32_32x32x16_bf16 v[32:47], v[92:95], v[96:99], v[32:47]
  ds_read_b128 v[144:147], v25 offset:20480
  ds_read_b128 v[148:151], v25 offset:25600
  v_mul_f32 v236, 0x3e64f92e, v236
  s_mov_b32 s40, 0
  s_mov_b32 s41, 8192
  v_mfma_f32_32x32x16_bf16 v[48:63], v[92:95], v[100:103], v[48:63]
  ds_read_b64_tr_b16 v[152:153], v4 offset:25600
  ds_read_b64_tr_b16 v[154:155], v4 offset:25760
  s_add_u32 s35, s36, 8192
  s_add_u32 s42, s35, 24576
  s_add_u32 s43, s36, 49152
  v_mfma_f32_32x32x16_bf16 v[64:79], v[92:95], v[28:31], v[64:79]
  ds_read_b128 v[156:159], v26 offset:20480
  ds_read_b128 v[160:163], v26 offset:25600
  s_add_u32 s39, s35, 73728
  s_and_b32 s32, s9, 3
  s_mul_i32 s32, s32, 10
  v_mfma_f32_32x32x16_bf16 v[32:47], v[104:107], v[108:111], v[32:47]
  ds_read_b64_tr_b16 v[164:165], v4 offset:28160
  ds_read_b64_tr_b16 v[166:167], v4 offset:28320
  s_mul_i32 s33, s8, 272
  s_add_u32 s32, s32, s33
  s_lshr_b32 s33, s9, 2
  v_mfma_f32_32x32x16_bf16 v[48:63], v[104:107], v[112:115], v[48:63]
  ds_read_b128 v[168:171], v27 offset:20480
  ds_read_b128 v[172:175], v27 offset:25600
  s_mul_i32 s33, s33, 5
  s_add_u32 s32, s32, s33
  s_add_u32 s16, s32, 4
  v_mfma_f32_32x32x16_bf16 v[64:79], v[104:107], v[28:31], v[64:79]
  s_lshl_b32 s16, s16, 10
  s_add_u32 s12, s32, s3
  s_lshl_b32 s12, s12, 10
  v_mfma_f32_32x32x16_bf16 v[32:47], v[116:119], v[120:123], v[32:47]
  s_add_u32 s13, s12, 139264
  s_add_u32 s17, s16, 139264
  s_lshl_b32 s14, s8, 3
  v_mfma_f32_32x32x16_bf16 v[48:63], v[116:119], v[124:127], v[48:63]
  s_add_u32 s14, s14, s9
  s_lshl_b32 s14, s14, 7
  s_add_u32 s14, s14, 69632
  v_mfma_f32_32x32x16_bf16 v[64:79], v[116:119], v[28:31], v[64:79]
  s_waitcnt lgkmcnt(0) vmcnt(0)
  s_barrier
  v_mfma_f32_32x32x16_bf16 v[32:47], v[128:131], v[132:135], v[32:47]
  ds_read_b128 v[176:179], v8 offset:0
  ds_read_b64 v[180:181], v9 offset:0
  v_mov_b32 v104, 0
  v_mov_b32 v105, 0
  v_mov_b32 v106, 0
  v_mov_b32 v107, 0
  v_mfma_f32_32x32x16_bf16 v[48:63], v[128:131], v[136:139], v[48:63]
  ds_read_b128 v[184:187], v8 offset:3072
  ds_read_b64 v[188:189], v9 offset:3072
  v_mov_b32 v108, 0
  v_mov_b32 v109, 0
  v_mov_b32 v110, 0
  v_mov_b32 v111, 0
  v_mfma_f32_32x32x16_bf16 v[64:79], v[128:131], v[28:31], v[64:79]
  ds_read_b128 v[192:195], v8 offset:6144
  ds_read_b64 v[196:197], v9 offset:6144
  v_mov_b32 v118, 0x3f803f80
  v_mov_b32 v119, 0
  v_mfma_f32_32x32x16_bf16 v[32:47], v[140:143], v[144:147], v[32:47]
  ds_read_b128 v[200:203], v8 offset:9216
  ds_read_b64 v[204:205], v9 offset:9216
  v_mov_b32 v134, 0x3f803f80
  v_mov_b32 v135, 0
  v_mov_b32 v136, 0
  v_mov_b32 v137, 0
  v_mfma_f32_32x32x16_bf16 v[48:63], v[140:143], v[148:151], v[48:63]
  ds_read_b128 v[120:123], v10
  ds_read_b128 v[124:127], v10 offset:768
  v_mov_b32 v138, 0
  v_mov_b32 v139, 0
  v_mfma_f32_32x32x16_bf16 v[64:79], v[140:143], v[28:31], v[64:79]
  ds_read_b128 v[112:115], v8 offset:0
  ds_read_b64 v[116:117], v9 offset:0
  v_mfma_f32_32x32x16_bf16 v[32:47], v[152:155], v[156:159], v[32:47]
  ds_read_b128 v[128:131], v8 offset:3072
  ds_read_b64 v[132:133], v9 offset:3072
  v_mov_b32 v140, 0
  v_mov_b32 v141, 0
  v_mov_b32 v142, 0
  v_mov_b32 v143, 0
  v_mfma_f32_32x32x16_bf16 v[48:63], v[152:155], v[160:163], v[48:63]
  v_mov_b32 v144, 0
  v_mov_b32 v145, 0
  v_mov_b32 v146, 0
  v_mov_b32 v147, 0
  v_mfma_f32_32x32x16_bf16 v[64:79], v[152:155], v[28:31], v[64:79]
  v_mov_b32 v148, 0
  v_mov_b32 v149, 0
  v_mov_b32 v150, 0
  v_mov_b32 v151, 0
  v_mfma_f32_32x32x16_bf16 v[32:47], v[164:167], v[168:171], v[32:47]
  v_mov_b32 v152, 0
  v_mov_b32 v153, 0
  v_mov_b32 v154, 0
  v_mov_b32 v155, 0
  v_mfma_f32_32x32x16_bf16 v[48:63], v[164:167], v[172:175], v[48:63]
  v_mov_b32 v156, 0
  v_mov_b32 v157, 0
  v_mov_b32 v158, 0
  v_mov_b32 v159, 0
  v_mfma_f32_32x32x16_bf16 v[64:79], v[164:167], v[28:31], v[64:79]
  v_mov_b32 v160, 0
  v_mov_b32 v161, 0
  v_mov_b32 v162, 0
  v_mov_b32 v163, 0
  v_mov_b32 v164, 0
  v_mov_b32 v165, 0
  v_mov_b32 v166, 0
  v_mov_b32 v167, 0
  v_mov_b32 v168, 0
  v_mov_b32 v169, 0
  v_mov_b32 v170, 0
  v_mov_b32 v171, 0
  v_fmac_f32 v32, v238, v64
  v_fmac_f32 v33, v238, v65
  v_fmac_f32 v34, v238, v66
  v_fmac_f32 v35, v238, v67
  v_fmac_f32 v36, v238, v68
  v_fmac_f32 v37, v238, v69
  v_fmac_f32 v38, v238, v70
  v_fmac_f32 v39, v238, v71
  v_fmac_f32 v40, v238, v72
  v_fmac_f32 v41, v238, v73
  v_fmac_f32 v42, v238, v74
  v_fmac_f32 v43, v238, v75
  v_mul_f32 v32, v234, v32
  v_mul_f32 v33, v234, v33
  v_mul_f32 v34, v234, v34
  v_mul_f32 v35, v234, v35
  v_mul_f32 v36, v234, v36
  v_mul_f32 v37, v234, v37
  v_mul_f32 v38, v234, v38
  v_mul_f32 v39, v234, v39
  v_mul_f32 v40, v234, v40
  v_mul_f32 v41, v234, v41
  v_mul_f32 v42, v234, v42
  v_mul_f32 v43, v234, v43
  v_cvt_pk_bf16_f32 v16, v32, v33
  v_cvt_pk_bf16_f32 v17, v34, v35
  v_cvt_pk_bf16_f32 v18, v36, v37
  v_cvt_pk_bf16_f32 v19, v38, v39
  v_cvt_pk_bf16_f32 v20, v40, v41
  v_cvt_pk_bf16_f32 v21, v42, v43
  v_mov_b32 v22, 0
  v_mov_b32 v23, 0
  s_waitcnt lgkmcnt(0)
  v_mfma_f32_32x32x16_bf16 v[80:95], v[176:179], v[16:19], 0
  s_add_u32 m0, s36, 8192
  s_add_u32 s32, s36, 24576
  v_fmac_f32 v48, v239, v64
  v_fmac_f32 v49, v239, v65
  v_fmac_f32 v50, v239, v66
  v_fmac_f32 v51, v239, v67
  v_fmac_f32 v52, v239, v68
  v_fmac_f32 v53, v239, v69
  v_mfma_f32_32x32x16_bf16 v[80:95], v[180:183], v[20:23], v[80:95]
  buffer_load_dwordx4 v2, s[24:27], s32 offen offset:0 sc1 lds
  v_fmac_f32 v54, v239, v70
  v_fmac_f32 v55, v239, v71
  v_fmac_f32 v56, v239, v72
  v_fmac_f32 v57, v239, v73
  v_fmac_f32 v58, v239, v74
  v_fmac_f32 v59, v239, v75
  v_mfma_f32_32x32x16_bf16 v[208:223], v[184:187], v[16:19], 0
  buffer_load_dwordx4 v2, s[24:27], s32 offen offset:1024 sc1 lds
  v_mul_f32 v48, v236, v48
  v_mul_f32 v49, v236, v49
  v_mul_f32 v50, v236, v50
  v_mul_f32 v51, v236, v51
  v_mul_f32 v52, v236, v52
  v_mul_f32 v53, v236, v53
  v_mfma_f32_32x32x16_bf16 v[208:223], v[188:191], v[20:23], v[208:223]
  buffer_load_dwordx4 v2, s[24:27], s32 offen offset:2048 sc1 lds
  v_mul_f32 v54, v236, v54
  v_mul_f32 v55, v236, v55
  v_mul_f32 v56, v236, v56
  v_mul_f32 v57, v236, v57
  v_mul_f32 v58, v236, v58
  v_mul_f32 v59, v236, v59
  v_mfma_f32_32x32x16_bf16 v[32:47], v[192:195], v[16:19], 0
  s_add_u32 m0, s36, 11264
  s_add_u32 s32, s36, 27648
  v_cvt_pk_bf16_f32 v24, v48, v49
  v_cvt_pk_bf16_f32 v25, v50, v51
  v_cvt_pk_bf16_f32 v26, v52, v53
  v_cvt_pk_bf16_f32 v27, v54, v55
  v_cvt_pk_bf16_f32 v28, v56, v57
  v_cvt_pk_bf16_f32 v29, v58, v59
  v_mfma_f32_32x32x16_bf16 v[32:47], v[196:199], v[20:23], v[32:47]
  buffer_load_dwordx4 v2, s[24:27], s32 offen offset:0 sc1 lds
  v_mov_b32 v30, 0
  v_mov_b32 v31, 0
  v_mfma_f32_32x32x16_bf16 v[64:79], v[200:203], v[16:19], 0
  buffer_load_dwordx4 v2, s[24:27], s32 offen offset:1024 sc1 lds
  v_max3_f32 v3, v80, v81, v82
  v_max_f32 v3, v3, v83
  v_max3_f32 v3, v3, v84, v85
  v_max3_f32 v3, v3, v86, v87
  v_max3_f32 v3, v3, v88, v89
  v_max3_f32 v3, v3, v90, v91
  v_mfma_f32_32x32x16_bf16 v[64:79], v[204:207], v[20:23], v[64:79]
  buffer_load_dwordx4 v2, s[24:27], s32 offen offset:2048 sc1 lds
  v_max3_f32 v3, v3, v92, v93
  v_max3_f32 v3, v3, v94, v95
  v_max3_f32 v3, v3, v208, v209
  v_max3_f32 v3, v3, v210, v211
  v_max3_f32 v3, v3, v212, v213
  v_max3_f32 v3, v3, v214, v215
  v_mfma_f32_32x32x16_bf16 v[48:63], v[176:179], v[24:27], 0
  v_max3_f32 v3, v3, v216, v217
  v_max3_f32 v3, v3, v218, v219
  v_max3_f32 v3, v3, v220, v221
  v_max3_f32 v3, v3, v222, v223
  v_mov_b32 v172, 0
  v_mov_b32 v173, 0
  v_mfma_f32_32x32x16_bf16 v[48:63], v[180:183], v[28:31], v[48:63]
  v_mov_b32 v174, 0
  v_mov_b32 v175, 0
  v_mfma_f32_32x32x16_bf16 v[80:95], v[184:187], v[24:27], 0
  v_max3_f32 v3, v3, v32, v33
  v_max3_f32 v3, v3, v34, v35
  v_max3_f32 v3, v3, v36, v37
  v_max3_f32 v3, v3, v38, v39
  v_max3_f32 v3, v3, v40, v41
  v_max3_f32 v3, v3, v42, v43
  v_mfma_f32_32x32x16_bf16 v[80:95], v[188:191], v[28:31], v[80:95]
  v_max3_f32 v3, v3, v44, v45
  v_max3_f32 v3, v3, v46, v47
  v_max3_f32 v3, v3, v64, v65
  v_max3_f32 v3, v3, v66, v67
  v_max3_f32 v3, v3, v68, v69
  v_max3_f32 v3, v3, v70, v71
  v_mfma_f32_32x32x16_bf16 v[208:223], v[192:195], v[24:27], 0
  v_max3_f32 v3, v3, v72, v73
  v_max3_f32 v3, v3, v74, v75
  v_max3_f32 v3, v3, v76, v77
  v_max3_f32 v3, v3, v78, v79
  v_mov_b32 v15, v3
  s_nop 1
  v_permlane32_swap_b32 v3, v15
  v_mfma_f32_32x32x16_bf16 v[208:223], v[196:199], v[28:31], v[208:223]
  v_max_f32 v3, v3, v15
  v_add_f32 v3, 0x42c00000, v3
  v_cvt_pk_bf16_f32 v15, 0, -v3
  v_cmp_ne_u32 vcc, 0, v6
  v_sub_f32 v3, -v3, v15
  v_cvt_pk_bf16_f32 v3, v3, v15
  v_cndmask_b32 v22, v3, 0, vcc
  s_waitcnt lgkmcnt(0)
  v_mfma_f32_32x32x16_bf16 v[64:79], v[200:203], v[24:27], 0
  v_max3_f32 v5, v48, v49, v50
  v_max_f32 v5, v5, v51
  v_max3_f32 v5, v5, v52, v53
  v_max3_f32 v5, v5, v54, v55
  v_max3_f32 v5, v5, v56, v57
  v_max3_f32 v5, v5, v58, v59
  v_mfma_f32_32x32x16_bf16 v[64:79], v[204:207], v[28:31], v[64:79]
  v_max3_f32 v5, v5, v60, v61
  v_max3_f32 v5, v5, v62, v63
  v_mov_b32 v60, 0
  v_mov_b32 v61, 0
  v_mov_b32 v62, 0
  v_mov_b32 v63, 0
  v_mfma_f32_32x32x16_bf16 v[32:47], v[112:115], v[16:19], 0
  v_max3_f32 v5, v5, v80, v81
  v_max3_f32 v5, v5, v82, v83
  v_max3_f32 v5, v5, v84, v85
  v_max3_f32 v5, v5, v86, v87
  v_max3_f32 v5, v5, v88, v89
  v_max3_f32 v5, v5, v90, v91
  v_mfma_f32_32x32x16_bf16 v[32:47], v[116:119], v[20:23], v[32:47]
  v_max3_f32 v5, v5, v92, v93
  v_max3_f32 v5, v5, v94, v95
  v_max3_f32 v5, v5, v208, v209
  v_max3_f32 v5, v5, v210, v211
  v_max3_f32 v5, v5, v212, v213
  v_max3_f32 v5, v5, v214, v215
  v_max3_f32 v5, v5, v216, v217
  v_max3_f32 v5, v5, v218, v219
  v_max3_f32 v5, v5, v220, v221
  v_max3_f32 v5, v5, v222, v223
  v_max3_f32 v5, v5, v64, v65
  v_max3_f32 v5, v5, v66, v67
  v_max3_f32 v5, v5, v68, v69
  v_max3_f32 v5, v5, v70, v71
  v_max3_f32 v5, v5, v72, v73
  v_max3_f32 v5, v5, v74, v75
  v_max3_f32 v5, v5, v76, v77
  v_max3_f32 v5, v5, v78, v79
  v_mov_b32 v15, v5
  s_nop 1
  v_permlane32_swap_b32 v5, v15
  v_max_f32 v5, v5, v15
  v_add_f32 v5, 0x42c00000, v5
  v_cvt_pk_bf16_f32 v15, 0, -v5
  v_cmp_ne_u32 vcc, 0, v6
  v_sub_f32 v5, -v5, v15
  v_cvt_pk_bf16_f32 v5, v5, v15
  v_cndmask_b32 v30, v5, 0, vcc
  s_mov_b32 s4, 256
  s_setprio 1
.p2align 6
parallel_sum__grouped_kv_mqa__swiglu_ffn__prompt_kernel_att53:
  v_exp_f32 v32, v32
  v_exp_f32 v33, v33
  v_mfma_f32_32x32x16_bf16 v[160:175], v[136:139], v[104:107], v[160:175]
  v_exp_f32 v34, v34
  v_exp_f32 v35, v35
  v_cvt_pk_bf16_f32 v110, v60, v61
  v_cvt_pk_bf16_f32 v111, v62, v63
  v_mfma_f32_32x32x16_bf16 v[48:63], v[112:115], v[24:27], 0
  v_exp_f32 v36, v36
  v_exp_f32 v37, v37
  v_exp_f32 v38, v38
  v_mfma_f32_32x32x16_bf16 v[48:63], v[116:119], v[28:31], v[48:63]
  s_waitcnt lgkmcnt(0)
  v_exp_f32 v39, v39
  v_cvt_pk_bf16_f32 v96, v32, v33
  v_cvt_pk_bf16_f32 v97, v34, v35
  v_exp_f32 v40, v40
  v_mfma_f32_32x32x16_bf16 v[160:175], v[140:143], v[108:111], v[160:175]
  ds_read_b128 v[112:115], v8 offset:6144
  ds_read_b64 v[116:117], v9 offset:6144
  v_exp_f32 v41, v41
  v_exp_f32 v42, v42
  v_exp_f32 v43, v43
  v_cvt_pk_bf16_f32 v98, v36, v37
  v_cvt_pk_bf16_f32 v99, v38, v39
  v_exp_f32 v44, v44
  v_exp_f32 v45, v45
  v_exp_f32 v46, v46
  v_exp_f32 v47, v47
  v_cvt_pk_bf16_f32 v100, v40, v41
  v_cvt_pk_bf16_f32 v101, v42, v43
  v_exp_f32 v48, v48
  v_exp_f32 v49, v49
  v_mfma_f32_32x32x16_bf16 v[144:159], v[120:123], v[96:99], v[144:159]
  v_exp_f32 v50, v50
  v_exp_f32 v51, v51
  v_cvt_pk_bf16_f32 v102, v44, v45
  v_cvt_pk_bf16_f32 v103, v46, v47
  v_mfma_f32_32x32x16_bf16 v[32:47], v[128:131], v[16:19], 0
  v_exp_f32 v52, v52
  v_exp_f32 v53, v53
  v_exp_f32 v54, v54
  v_mfma_f32_32x32x16_bf16 v[32:47], v[132:135], v[20:23], v[32:47]
  v_exp_f32 v55, v55
  v_cvt_pk_bf16_f32 v104, v48, v49
  v_cvt_pk_bf16_f32 v105, v50, v51
  v_exp_f32 v56, v56
  v_mfma_f32_32x32x16_bf16 v[144:159], v[124:127], v[100:103], v[144:159]
  ds_read_b128 v[136:139], v10 offset:3072
  ds_read_b128 v[140:143], v10 offset:3840
  v_exp_f32 v57, v57
  v_exp_f32 v58, v58
  v_exp_f32 v59, v59
  v_cvt_pk_bf16_f32 v106, v52, v53
  v_cvt_pk_bf16_f32 v107, v54, v55
  v_exp_f32 v60, v60
  v_exp_f32 v61, v61
  v_exp_f32 v62, v62
  v_exp_f32 v63, v63
  v_cvt_pk_bf16_f32 v108, v56, v57
  v_cvt_pk_bf16_f32 v109, v58, v59
  v_exp_f32 v32, v32
  v_exp_f32 v33, v33
  v_mfma_f32_32x32x16_bf16 v[160:175], v[120:123], v[104:107], v[160:175]
  v_exp_f32 v34, v34
  v_exp_f32 v35, v35
  v_cvt_pk_bf16_f32 v110, v60, v61
  v_cvt_pk_bf16_f32 v111, v62, v63
  v_mfma_f32_32x32x16_bf16 v[48:63], v[128:131], v[24:27], 0
  v_exp_f32 v36, v36
  v_exp_f32 v37, v37
  v_exp_f32 v38, v38
  v_mfma_f32_32x32x16_bf16 v[48:63], v[132:135], v[28:31], v[48:63]
  s_waitcnt lgkmcnt(0)
  v_exp_f32 v39, v39
  v_cvt_pk_bf16_f32 v96, v32, v33
  v_cvt_pk_bf16_f32 v97, v34, v35
  v_exp_f32 v40, v40
  v_mfma_f32_32x32x16_bf16 v[160:175], v[124:127], v[108:111], v[160:175]
  ds_read_b128 v[128:131], v8 offset:9216
  ds_read_b64 v[132:133], v9 offset:9216
  v_exp_f32 v41, v41
  v_exp_f32 v42, v42
  v_exp_f32 v43, v43
  v_cvt_pk_bf16_f32 v98, v36, v37
  v_cvt_pk_bf16_f32 v99, v38, v39
  v_exp_f32 v44, v44
  v_exp_f32 v45, v45
  v_exp_f32 v46, v46
  v_exp_f32 v47, v47
  v_cvt_pk_bf16_f32 v100, v40, v41
  v_cvt_pk_bf16_f32 v101, v42, v43
  v_exp_f32 v48, v48
  v_exp_f32 v49, v49
  v_mfma_f32_32x32x16_bf16 v[144:159], v[136:139], v[96:99], v[144:159]
  s_mov_b32 m0, s42
  v_exp_f32 v50, v50
  v_exp_f32 v51, v51
  v_cvt_pk_bf16_f32 v102, v44, v45
  v_cvt_pk_bf16_f32 v103, v46, v47
  v_mfma_f32_32x32x16_bf16 v[32:47], v[112:115], v[16:19], 0
  s_add_u32 s38, s43, 4096
  v_exp_f32 v52, v52
  v_exp_f32 v53, v53
  v_exp_f32 v54, v54
  v_mfma_f32_32x32x16_bf16 v[32:47], v[116:119], v[20:23], v[32:47]
  v_exp_f32 v55, v55
  v_cvt_pk_bf16_f32 v104, v48, v49
  v_cvt_pk_bf16_f32 v105, v50, v51
  v_exp_f32 v56, v56
  v_mfma_f32_32x32x16_bf16 v[144:159], v[140:143], v[100:103], v[144:159]
  ds_read_b128 v[120:123], v10 offset:6144
  ds_read_b128 v[124:127], v10 offset:6912
  s_waitcnt vmcnt(0)
  s_barrier
  v_exp_f32 v57, v57
  v_exp_f32 v58, v58
  v_exp_f32 v59, v59
  v_cvt_pk_bf16_f32 v106, v52, v53
  v_cvt_pk_bf16_f32 v107, v54, v55
  v_exp_f32 v60, v60
  v_exp_f32 v61, v61
  v_exp_f32 v62, v62
  v_exp_f32 v63, v63
  v_cvt_pk_bf16_f32 v108, v56, v57
  v_cvt_pk_bf16_f32 v109, v58, v59
  v_exp_f32 v32, v32
  v_exp_f32 v33, v33
  v_mfma_f32_32x32x16_bf16 v[160:175], v[136:139], v[104:107], v[160:175]
  v_exp_f32 v34, v34
  v_exp_f32 v35, v35
  v_cvt_pk_bf16_f32 v110, v60, v61
  v_cvt_pk_bf16_f32 v111, v62, v63
  v_mfma_f32_32x32x16_bf16 v[48:63], v[112:115], v[24:27], 0
  v_exp_f32 v36, v36
  v_exp_f32 v37, v37
  v_exp_f32 v38, v38
  v_mfma_f32_32x32x16_bf16 v[48:63], v[116:119], v[28:31], v[48:63]
  s_waitcnt lgkmcnt(0)
  v_exp_f32 v39, v39
  v_cvt_pk_bf16_f32 v96, v32, v33
  v_cvt_pk_bf16_f32 v97, v34, v35
  v_exp_f32 v40, v40
  v_mfma_f32_32x32x16_bf16 v[160:175], v[140:143], v[108:111], v[160:175]
  ds_read_b128 v[112:115], v8 offset:12288
  ds_read_b64 v[116:117], v9 offset:12288
  v_exp_f32 v41, v41
  v_exp_f32 v42, v42
  v_exp_f32 v43, v43
  v_cvt_pk_bf16_f32 v98, v36, v37
  v_cvt_pk_bf16_f32 v99, v38, v39
  v_exp_f32 v44, v44
  v_exp_f32 v45, v45
  v_exp_f32 v46, v46
  v_exp_f32 v47, v47
  v_cvt_pk_bf16_f32 v100, v40, v41
  v_cvt_pk_bf16_f32 v101, v42, v43
  v_exp_f32 v48, v48
  v_exp_f32 v49, v49
  v_mfma_f32_32x32x16_bf16 v[144:159], v[120:123], v[96:99], v[144:159]
  v_exp_f32 v50, v50
  v_exp_f32 v51, v51
  v_cvt_pk_bf16_f32 v102, v44, v45
  v_cvt_pk_bf16_f32 v103, v46, v47
  v_mfma_f32_32x32x16_bf16 v[32:47], v[128:131], v[16:19], 0
  v_exp_f32 v52, v52
  v_exp_f32 v53, v53
  v_exp_f32 v54, v54
  v_mfma_f32_32x32x16_bf16 v[32:47], v[132:135], v[20:23], v[32:47]
  v_exp_f32 v55, v55
  v_cvt_pk_bf16_f32 v104, v48, v49
  v_cvt_pk_bf16_f32 v105, v50, v51
  v_exp_f32 v56, v56
  v_mfma_f32_32x32x16_bf16 v[144:159], v[124:127], v[100:103], v[144:159]
  ds_read_b128 v[136:139], v10 offset:9216
  ds_read_b128 v[140:143], v10 offset:9984
  buffer_load_dwordx4 v2, s[24:27], s43 offen offset:0 sc1 lds
  buffer_load_dwordx4 v2, s[24:27], s43 offen offset:1024 sc1 lds
  v_exp_f32 v57, v57
  v_exp_f32 v58, v58
  v_exp_f32 v59, v59
  v_cvt_pk_bf16_f32 v106, v52, v53
  v_cvt_pk_bf16_f32 v107, v54, v55
  v_exp_f32 v60, v60
  v_exp_f32 v61, v61
  v_exp_f32 v62, v62
  v_exp_f32 v63, v63
  v_cvt_pk_bf16_f32 v108, v56, v57
  v_cvt_pk_bf16_f32 v109, v58, v59
  v_exp_f32 v32, v32
  v_exp_f32 v33, v33
  v_mfma_f32_32x32x16_bf16 v[160:175], v[120:123], v[104:107], v[160:175]
  v_exp_f32 v34, v34
  v_exp_f32 v35, v35
  v_cvt_pk_bf16_f32 v110, v60, v61
  v_cvt_pk_bf16_f32 v111, v62, v63
  v_mfma_f32_32x32x16_bf16 v[48:63], v[128:131], v[24:27], 0
  v_exp_f32 v36, v36
  v_exp_f32 v37, v37
  v_exp_f32 v38, v38
  v_mfma_f32_32x32x16_bf16 v[48:63], v[132:135], v[28:31], v[48:63]
  s_waitcnt lgkmcnt(0)
  v_exp_f32 v39, v39
  v_cvt_pk_bf16_f32 v96, v32, v33
  v_cvt_pk_bf16_f32 v97, v34, v35
  v_exp_f32 v40, v40
  v_mfma_f32_32x32x16_bf16 v[160:175], v[124:127], v[108:111], v[160:175]
  ds_read_b128 v[128:131], v8 offset:15360
  ds_read_b64 v[132:133], v9 offset:15360
  v_exp_f32 v41, v41
  v_exp_f32 v42, v42
  v_exp_f32 v43, v43
  v_cvt_pk_bf16_f32 v98, v36, v37
  v_cvt_pk_bf16_f32 v99, v38, v39
  v_exp_f32 v44, v44
  v_exp_f32 v45, v45
  v_exp_f32 v46, v46
  v_exp_f32 v47, v47
  v_cvt_pk_bf16_f32 v100, v40, v41
  v_cvt_pk_bf16_f32 v101, v42, v43
  v_exp_f32 v48, v48
  v_exp_f32 v49, v49
  v_mfma_f32_32x32x16_bf16 v[144:159], v[136:139], v[96:99], v[144:159]
  v_exp_f32 v50, v50
  v_exp_f32 v51, v51
  v_cvt_pk_bf16_f32 v102, v44, v45
  v_cvt_pk_bf16_f32 v103, v46, v47
  v_mfma_f32_32x32x16_bf16 v[32:47], v[112:115], v[16:19], 0
  v_exp_f32 v52, v52
  v_exp_f32 v53, v53
  v_exp_f32 v54, v54
  v_mfma_f32_32x32x16_bf16 v[32:47], v[116:119], v[20:23], v[32:47]
  v_exp_f32 v55, v55
  v_cvt_pk_bf16_f32 v104, v48, v49
  v_cvt_pk_bf16_f32 v105, v50, v51
  v_exp_f32 v56, v56
  v_mfma_f32_32x32x16_bf16 v[144:159], v[140:143], v[100:103], v[144:159]
  ds_read_b128 v[120:123], v10 offset:12288
  ds_read_b128 v[124:127], v10 offset:13056
  buffer_load_dwordx4 v2, s[24:27], s43 offen offset:2048 sc1 lds
  buffer_load_dwordx4 v2, s[24:27], s43 offen offset:3072 sc1 lds
  v_exp_f32 v57, v57
  v_exp_f32 v58, v58
  v_exp_f32 v59, v59
  v_cvt_pk_bf16_f32 v106, v52, v53
  v_cvt_pk_bf16_f32 v107, v54, v55
  v_exp_f32 v60, v60
  v_exp_f32 v61, v61
  v_exp_f32 v62, v62
  v_exp_f32 v63, v63
  v_cvt_pk_bf16_f32 v108, v56, v57
  v_cvt_pk_bf16_f32 v109, v58, v59
  v_exp_f32 v32, v32
  v_exp_f32 v33, v33
  v_mfma_f32_32x32x16_bf16 v[160:175], v[136:139], v[104:107], v[160:175]
  v_exp_f32 v34, v34
  v_exp_f32 v35, v35
  v_cvt_pk_bf16_f32 v110, v60, v61
  v_cvt_pk_bf16_f32 v111, v62, v63
  v_mfma_f32_32x32x16_bf16 v[48:63], v[112:115], v[24:27], 0
  v_exp_f32 v36, v36
  v_exp_f32 v37, v37
  v_exp_f32 v38, v38
  v_mfma_f32_32x32x16_bf16 v[48:63], v[116:119], v[28:31], v[48:63]
  s_waitcnt lgkmcnt(0)
  v_exp_f32 v39, v39
  v_cvt_pk_bf16_f32 v96, v32, v33
  v_cvt_pk_bf16_f32 v97, v34, v35
  v_exp_f32 v40, v40
  v_mfma_f32_32x32x16_bf16 v[160:175], v[140:143], v[108:111], v[160:175]
  ds_read_b128 v[112:115], v8 offset:18432
  ds_read_b64 v[116:117], v9 offset:18432
  v_exp_f32 v41, v41
  v_exp_f32 v42, v42
  v_exp_f32 v43, v43
  v_cvt_pk_bf16_f32 v98, v36, v37
  v_cvt_pk_bf16_f32 v99, v38, v39
  v_exp_f32 v44, v44
  v_exp_f32 v45, v45
  v_exp_f32 v46, v46
  v_exp_f32 v47, v47
  v_cvt_pk_bf16_f32 v100, v40, v41
  v_cvt_pk_bf16_f32 v101, v42, v43
  v_exp_f32 v48, v48
  v_exp_f32 v49, v49
  v_mfma_f32_32x32x16_bf16 v[144:159], v[120:123], v[96:99], v[144:159]
  s_add_u32 m0, s42, 4096
  v_exp_f32 v50, v50
  v_exp_f32 v51, v51
  v_cvt_pk_bf16_f32 v102, v44, v45
  v_cvt_pk_bf16_f32 v103, v46, v47
  v_mfma_f32_32x32x16_bf16 v[32:47], v[128:131], v[16:19], 0
  v_exp_f32 v52, v52
  v_exp_f32 v53, v53
  v_exp_f32 v54, v54
  v_mfma_f32_32x32x16_bf16 v[32:47], v[132:135], v[20:23], v[32:47]
  v_exp_f32 v55, v55
  v_cvt_pk_bf16_f32 v104, v48, v49
  v_cvt_pk_bf16_f32 v105, v50, v51
  v_exp_f32 v56, v56
  v_mfma_f32_32x32x16_bf16 v[144:159], v[124:127], v[100:103], v[144:159]
  ds_read_b128 v[136:139], v10 offset:15360
  ds_read_b128 v[140:143], v10 offset:16128
  buffer_load_dwordx4 v2, s[24:27], s38 offen offset:0 sc1 lds
  buffer_load_dwordx4 v2, s[24:27], s38 offen offset:1024 sc1 lds
  v_exp_f32 v57, v57
  v_exp_f32 v58, v58
  v_exp_f32 v59, v59
  v_cvt_pk_bf16_f32 v106, v52, v53
  v_cvt_pk_bf16_f32 v107, v54, v55
  v_exp_f32 v60, v60
  v_exp_f32 v61, v61
  v_exp_f32 v62, v62
  v_exp_f32 v63, v63
  v_cvt_pk_bf16_f32 v108, v56, v57
  v_cvt_pk_bf16_f32 v109, v58, v59
  v_exp_f32 v32, v32
  v_exp_f32 v33, v33
  v_mfma_f32_32x32x16_bf16 v[160:175], v[120:123], v[104:107], v[160:175]
  v_exp_f32 v34, v34
  v_exp_f32 v35, v35
  v_cvt_pk_bf16_f32 v110, v60, v61
  v_cvt_pk_bf16_f32 v111, v62, v63
  v_mfma_f32_32x32x16_bf16 v[48:63], v[128:131], v[24:27], 0
  v_exp_f32 v36, v36
  v_exp_f32 v37, v37
  v_exp_f32 v38, v38
  v_mfma_f32_32x32x16_bf16 v[48:63], v[132:135], v[28:31], v[48:63]
  s_waitcnt lgkmcnt(0)
  v_exp_f32 v39, v39
  v_cvt_pk_bf16_f32 v96, v32, v33
  v_cvt_pk_bf16_f32 v97, v34, v35
  v_exp_f32 v40, v40
  v_mfma_f32_32x32x16_bf16 v[160:175], v[124:127], v[108:111], v[160:175]
  ds_read_b128 v[128:131], v8 offset:21504
  ds_read_b64 v[132:133], v9 offset:21504
  v_exp_f32 v41, v41
  v_exp_f32 v42, v42
  v_exp_f32 v43, v43
  v_cvt_pk_bf16_f32 v98, v36, v37
  v_cvt_pk_bf16_f32 v99, v38, v39
  v_exp_f32 v44, v44
  v_exp_f32 v45, v45
  v_exp_f32 v46, v46
  v_exp_f32 v47, v47
  v_cvt_pk_bf16_f32 v100, v40, v41
  v_cvt_pk_bf16_f32 v101, v42, v43
  v_exp_f32 v48, v48
  v_exp_f32 v49, v49
  v_mfma_f32_32x32x16_bf16 v[144:159], v[136:139], v[96:99], v[144:159]
  s_add_u32 s43, s43, 24576
  v_exp_f32 v50, v50
  v_exp_f32 v51, v51
  v_cvt_pk_bf16_f32 v102, v44, v45
  v_cvt_pk_bf16_f32 v103, v46, v47
  v_mfma_f32_32x32x16_bf16 v[32:47], v[112:115], v[16:19], 0
  s_add_u32 s40, s40, 1
  v_exp_f32 v52, v52
  v_exp_f32 v53, v53
  v_exp_f32 v54, v54
  v_mfma_f32_32x32x16_bf16 v[32:47], v[116:119], v[20:23], v[32:47]
  s_add_u32 s37, s42, 24576
  v_exp_f32 v55, v55
  v_cvt_pk_bf16_f32 v104, v48, v49
  v_cvt_pk_bf16_f32 v105, v50, v51
  v_exp_f32 v56, v56
  v_mfma_f32_32x32x16_bf16 v[144:159], v[140:143], v[100:103], v[144:159]
  ds_read_b128 v[120:123], v10 offset:18432
  ds_read_b128 v[124:127], v10 offset:19200
  v_exp_f32 v57, v57
  v_exp_f32 v58, v58
  v_exp_f32 v59, v59
  v_cvt_pk_bf16_f32 v106, v52, v53
  v_cvt_pk_bf16_f32 v107, v54, v55
  v_exp_f32 v60, v60
  v_exp_f32 v61, v61
  v_exp_f32 v62, v62
  v_exp_f32 v63, v63
  v_cvt_pk_bf16_f32 v108, v56, v57
  v_cvt_pk_bf16_f32 v109, v58, v59
  v_add_u32 v8, s41, v2
  v_add_u32 v9, s41, v11
  v_exp_f32 v32, v32
  v_exp_f32 v33, v33
  v_mfma_f32_32x32x16_bf16 v[160:175], v[136:139], v[104:107], v[160:175]
  v_exp_f32 v34, v34
  v_exp_f32 v35, v35
  v_cvt_pk_bf16_f32 v110, v60, v61
  v_cvt_pk_bf16_f32 v111, v62, v63
  v_mfma_f32_32x32x16_bf16 v[48:63], v[112:115], v[24:27], 0
  v_exp_f32 v36, v36
  v_exp_f32 v37, v37
  v_exp_f32 v38, v38
  v_mfma_f32_32x32x16_bf16 v[48:63], v[116:119], v[28:31], v[48:63]
  s_waitcnt lgkmcnt(0)
  v_exp_f32 v39, v39
  v_cvt_pk_bf16_f32 v96, v32, v33
  v_cvt_pk_bf16_f32 v97, v34, v35
  v_exp_f32 v40, v40
  v_mfma_f32_32x32x16_bf16 v[160:175], v[140:143], v[108:111], v[160:175]
  ds_read_b128 v[112:115], v8 offset:0
  ds_read_b64 v[116:117], v9 offset:0
  v_exp_f32 v41, v41
  v_exp_f32 v42, v42
  v_exp_f32 v43, v43
  v_cvt_pk_bf16_f32 v98, v36, v37
  v_cvt_pk_bf16_f32 v99, v38, v39
  v_exp_f32 v44, v44
  v_exp_f32 v45, v45
  v_exp_f32 v46, v46
  v_exp_f32 v47, v47
  v_cvt_pk_bf16_f32 v100, v40, v41
  v_cvt_pk_bf16_f32 v101, v42, v43
  v_exp_f32 v48, v48
  v_exp_f32 v49, v49
  v_mfma_f32_32x32x16_bf16 v[144:159], v[120:123], v[96:99], v[144:159]
  s_cmp_eq_u32 s37, s39
  v_exp_f32 v50, v50
  v_exp_f32 v51, v51
  v_cvt_pk_bf16_f32 v102, v44, v45
  v_cvt_pk_bf16_f32 v103, v46, v47
  v_mfma_f32_32x32x16_bf16 v[32:47], v[128:131], v[16:19], 0
  s_cselect_b32 s37, s35, s37
  v_exp_f32 v52, v52
  v_exp_f32 v53, v53
  v_exp_f32 v54, v54
  v_mfma_f32_32x32x16_bf16 v[32:47], v[132:135], v[20:23], v[32:47]
  v_exp_f32 v55, v55
  v_cvt_pk_bf16_f32 v104, v48, v49
  v_cvt_pk_bf16_f32 v105, v50, v51
  v_exp_f32 v56, v56
  v_mfma_f32_32x32x16_bf16 v[144:159], v[124:127], v[100:103], v[144:159]
  ds_read_b128 v[136:139], v10 offset:21504
  ds_read_b128 v[140:143], v10 offset:22272
  v_exp_f32 v57, v57
  v_exp_f32 v58, v58
  v_exp_f32 v59, v59
  v_cvt_pk_bf16_f32 v106, v52, v53
  v_cvt_pk_bf16_f32 v107, v54, v55
  v_exp_f32 v60, v60
  v_exp_f32 v61, v61
  v_exp_f32 v62, v62
  v_exp_f32 v63, v63
  v_cvt_pk_bf16_f32 v108, v56, v57
  v_cvt_pk_bf16_f32 v109, v58, v59
  v_add_u32 v10, s41, v12
  v_exp_f32 v32, v32
  v_exp_f32 v33, v33
  v_mfma_f32_32x32x16_bf16 v[160:175], v[120:123], v[104:107], v[160:175]
  v_exp_f32 v34, v34
  v_exp_f32 v35, v35
  v_cvt_pk_bf16_f32 v110, v60, v61
  v_cvt_pk_bf16_f32 v111, v62, v63
  v_mfma_f32_32x32x16_bf16 v[48:63], v[128:131], v[24:27], 0
  v_exp_f32 v36, v36
  v_exp_f32 v37, v37
  v_exp_f32 v38, v38
  v_mfma_f32_32x32x16_bf16 v[48:63], v[132:135], v[28:31], v[48:63]
  s_waitcnt lgkmcnt(0)
  v_exp_f32 v39, v39
  v_cvt_pk_bf16_f32 v96, v32, v33
  v_cvt_pk_bf16_f32 v97, v34, v35
  v_exp_f32 v40, v40
  v_mfma_f32_32x32x16_bf16 v[160:175], v[124:127], v[108:111], v[160:175]
  ds_read_b128 v[128:131], v8 offset:3072
  ds_read_b64 v[132:133], v9 offset:3072
  v_exp_f32 v41, v41
  v_exp_f32 v42, v42
  v_exp_f32 v43, v43
  v_cvt_pk_bf16_f32 v98, v36, v37
  v_cvt_pk_bf16_f32 v99, v38, v39
  v_exp_f32 v44, v44
  v_exp_f32 v45, v45
  v_exp_f32 v46, v46
  v_exp_f32 v47, v47
  v_cvt_pk_bf16_f32 v100, v40, v41
  v_cvt_pk_bf16_f32 v101, v42, v43
  v_exp_f32 v48, v48
  v_exp_f32 v49, v49
  v_mfma_f32_32x32x16_bf16 v[144:159], v[136:139], v[96:99], v[144:159]
  s_sub_u32 s41, s42, s36
  v_exp_f32 v50, v50
  v_exp_f32 v51, v51
  v_cvt_pk_bf16_f32 v102, v44, v45
  v_cvt_pk_bf16_f32 v103, v46, v47
  v_mfma_f32_32x32x16_bf16 v[32:47], v[112:115], v[16:19], 0
  s_mov_b32 s42, s37
  v_exp_f32 v52, v52
  v_exp_f32 v53, v53
  v_exp_f32 v54, v54
  v_mfma_f32_32x32x16_bf16 v[32:47], v[116:119], v[20:23], v[32:47]
  s_bitcmp0_b32 s4, s40
  v_exp_f32 v55, v55
  v_cvt_pk_bf16_f32 v104, v48, v49
  v_cvt_pk_bf16_f32 v105, v50, v51
  v_exp_f32 v56, v56
  v_mfma_f32_32x32x16_bf16 v[144:159], v[140:143], v[100:103], v[144:159]
  ds_read_b128 v[120:123], v10 offset:0
  ds_read_b128 v[124:127], v10 offset:768
  v_exp_f32 v57, v57
  v_exp_f32 v58, v58
  v_exp_f32 v59, v59
  v_cvt_pk_bf16_f32 v106, v52, v53
  v_cvt_pk_bf16_f32 v107, v54, v55
  v_exp_f32 v60, v60
  v_exp_f32 v61, v61
  v_exp_f32 v62, v62
  v_exp_f32 v63, v63
  v_cvt_pk_bf16_f32 v108, v56, v57
  v_cvt_pk_bf16_f32 v109, v58, v59
  s_cbranch_scc1 parallel_sum__grouped_kv_mqa__swiglu_ffn__prompt_kernel_att53
  v_cvt_pk_bf16_f32 v110, v60, v61
  v_cvt_pk_bf16_f32 v111, v62, v63
  v_mfma_f32_32x32x16_bf16 v[160:175], v[136:139], v[104:107], v[160:175]
  s_nop 0
  v_mfma_f32_32x32x16_bf16 v[160:175], v[140:143], v[108:111], v[160:175]
  s_mov_b32 s40, 0
  s_setprio 3
parallel_sum__grouped_kv_mqa__swiglu_ffn__prompt_kernel_out54:
  v_rcp_f32 v208, v156
  s_nop 0
  v_mul_f32 v208, 0x3f317218, v208
  v_mul_f32 v144, v144, v208
  v_mul_f32 v145, v145, v208
  v_mul_f32 v146, v146, v208
  v_mul_f32 v147, v147, v208
  v_mul_f32 v148, v148, v208
  v_mul_f32 v149, v149, v208
  v_mul_f32 v150, v150, v208
  v_mul_f32 v151, v151, v208
  v_mul_f32 v152, v152, v208
  v_mul_f32 v153, v153, v208
  v_mul_f32 v154, v154, v208
  v_mul_f32 v155, v155, v208
  v_cvt_pk_bf16_f32 v224, v144, v145
  v_cvt_pk_bf16_f32 v225, v146, v147
  v_cvt_pk_bf16_f32 v226, v148, v149
  v_cvt_pk_bf16_f32 v227, v150, v151
  v_cvt_pk_bf16_f32 v228, v152, v153
  v_cvt_pk_bf16_f32 v229, v154, v155
  buffer_store_dwordx4 v[224:227], v2, s[28:31], s12 offen sc1
  buffer_store_dwordx2 v[228:229], v241, s[28:31], s16 offen sc1
  v_rcp_f32 v209, v172
  s_nop 0
  v_mul_f32 v209, 0x3f317218, v209
  v_mul_f32 v160, v160, v209
  v_mul_f32 v161, v161, v209
  v_mul_f32 v162, v162, v209
  v_mul_f32 v163, v163, v209
  v_mul_f32 v164, v164, v209
  v_mul_f32 v165, v165, v209
  v_mul_f32 v166, v166, v209
  v_mul_f32 v167, v167, v209
  v_mul_f32 v168, v168, v209
  v_mul_f32 v169, v169, v209
  v_mul_f32 v170, v170, v209
  v_mul_f32 v171, v171, v209
  v_cvt_pk_bf16_f32 v232, v160, v161
  v_cvt_pk_bf16_f32 v233, v162, v163
  v_cvt_pk_bf16_f32 v234, v164, v165
  v_cvt_pk_bf16_f32 v235, v166, v167
  v_cvt_pk_bf16_f32 v236, v168, v169
  v_cvt_pk_bf16_f32 v237, v170, v171
  buffer_store_dwordx4 v[232:235], v2, s[28:31], s13 offen sc1
  buffer_store_dwordx2 v[236:237], v241, s[28:31], s17 offen sc1
  v_mul_f32 v210, 0, v156
  v_mul_f32 v211, 0, v144
  v_fma_f32 v211, v145, 0, v211
  v_fma_f32 v210, v146, 0, v210
  v_fma_f32 v211, v147, 0, v211
  v_fma_f32 v210, v148, 0, v210
  v_fma_f32 v211, v149, 0, v211
  v_fma_f32 v210, v150, 0, v210
  v_fma_f32 v211, v151, 0, v211
  v_fma_f32 v210, v152, 0, v210
  v_fma_f32 v211, v153, 0, v211
  v_fma_f32 v210, v154, 0, v210
  v_fma_f32 v211, v155, 0, v211
  v_mul_f32 v212, 0, v172
  v_mul_f32 v213, 0, v160
  v_fma_f32 v213, v161, 0, v213
  v_fma_f32 v212, v162, 0, v212
  v_fma_f32 v213, v163, 0, v213
  v_fma_f32 v212, v164, 0, v212
  v_fma_f32 v213, v165, 0, v213
  v_fma_f32 v212, v166, 0, v212
  v_fma_f32 v213, v167, 0, v213
  v_fma_f32 v212, v168, 0, v212
  v_fma_f32 v213, v169, 0, v213
  v_fma_f32 v212, v170, 0, v212
  v_fma_f32 v213, v171, 0, v213
  v_add_f32 v210, v210, v212
  v_add_f32 v211, v211, v213
  v_cmp_u_f32 vcc, v210, v211
  s_cmp_lg_u32 s40, 0
  s_cbranch_scc1 parallel_sum__grouped_kv_mqa__swiglu_ffn__prompt_kernel_pub56
  s_cmp_lg_u64 vcc, 0
  s_cbranch_scc1 parallel_sum__grouped_kv_mqa__swiglu_ffn__prompt_kernel_slow55
parallel_sum__grouped_kv_mqa__swiglu_ffn__prompt_kernel_pub56:
  s_waitcnt vmcnt(0)
  s_barrier
  s_cmp_lg_u32 s3, 0
  s_cbranch_scc1 parallel_sum__grouped_kv_mqa__swiglu_ffn__prompt_kernel_nofl57
  v_mov_b32 v16, s73
  v_mov_b32 v17, 0
  s_mov_b64 exec, 1
  buffer_store_dword v16, v17, s[44:47], s14 offen sc1
  s_mov_b64 exec, -1
parallel_sum__grouped_kv_mqa__swiglu_ffn__prompt_kernel_nofl57:
  s_or_b32 s32, s2, s3
  s_cmp_lg_u32 s32, 0
  s_cbranch_scc1 parallel_sum__grouped_kv_mqa__swiglu_ffn__prompt_kernel_axit58
  v_lshlrev_b32 v13, 7, v1
parallel_sum__grouped_kv_mqa__swiglu_ffn__prompt_kernel_poll59:
  s_mov_b32 s38, 36864
  buffer_load_dword v16, v13, s[44:47], s38 offen sc1
  s_mov_b32 s38, 45056
  buffer_load_dword v17, v13, s[44:47], s38 offen sc1
  s_mov_b32 s38, 53248
  buffer_load_dword v18, v13, s[44:47], s38 offen sc1
  s_mov_b32 s38, 61440
  buffer_load_dword v19, v13, s[44:47], s38 offen sc1
  s_mov_b32 s38, 69632
  buffer_load_dword v20, v13, s[44:47], s38 offen sc1
  s_mov_b32 s38, 77824
  buffer_load_dword v21, v13, s[44:47], s38 offen sc1
  s_mov_b32 s38, 86016
  buffer_load_dword v22, v13, s[44:47], s38 offen sc1
  s_mov_b32 s38, 94208
  buffer_load_dword v23, v13, s[44:47], s38 offen sc1
parallel_sum__grouped_kv_mqa__swiglu_ffn__prompt_kernel_pchk61:
  s_waitcnt vmcnt(0)
  v_xor_b32 v24, s73, v16
  v_xor_b32 v17, s73, v17
  v_or_b32 v24, v24, v17
  v_xor_b32 v18, s73, v18
  v_or_b32 v24, v24, v18
  v_xor_b32 v19, s73, v19
  v_or_b32 v24, v24, v19
  v_xor_b32 v20, s73, v20
  v_or_b32 v24, v24, v20
  v_xor_b32 v21, s73, v21
  v_or_b32 v24, v24, v21
  v_xor_b32 v22, s73, v22
  v_or_b32 v24, v24, v22
  v_xor_b32 v23, s73, v23
  v_or_b32 v24, v24, v23
  v_cmp_ne_u32 vcc, 0, v24
  s_nop 0
  s_cmp_eq_u64 vcc, 0
  s_cbranch_scc1 parallel_sum__grouped_kv_mqa__swiglu_ffn__prompt_kernel_pdone60
  s_cmp_eq_u32 s74, 0
  s_cbranch_scc1 parallel_sum__grouped_kv_mqa__swiglu_ffn__prompt_kernel_pdone60
  s_sub_u32 s74, s74, 1
  s_sleep 1
  s_branch parallel_sum__grouped_kv_mqa__swiglu_ffn__prompt_kernel_poll59
parallel_sum__grouped_kv_mqa__swiglu_ffn__prompt_kernel_pdone60:
  s_cmp_lg_u32 s3, 0
  s_cbranch_scc1 parallel_sum__grouped_kv_mqa__swiglu_ffn__prompt_kernel_nofl62
  v_mov_b32 v16, s73
  v_mov_b32 v17, 0
  s_mov_b64 exec, 1
  buffer_store_dword v16, v17, s[44:47], 0 offen sc1
  s_mov_b64 exec, -1
parallel_sum__grouped_kv_mqa__swiglu_ffn__prompt_kernel_nofl62:
parallel_sum__grouped_kv_mqa__swiglu_ffn__prompt_kernel_axit58:
  s_endpgm
parallel_sum__grouped_kv_mqa__swiglu_ffn__prompt_kernel_slow55:
  s_waitcnt vmcnt(0) lgkmcnt(0)
  s_mov_b32 s40, 1
  s_mov_b32 s41, 0
  v_mov_b32 v22, 0
  v_mov_b32 v30, 0
  v_mov_b32 v3, 0xff800000
  v_mov_b32 v5, 0xff800000
parallel_sum__grouped_kv_mqa__swiglu_ffn__prompt_kernel_sl163:
  buffer_load_dwordx4 v[112:115], v2, s[24:27], s41 offen sc1
  buffer_load_dwordx2 v[116:117], v11, s[24:27], s41 offen sc1
  s_waitcnt vmcnt(0)
  v_mfma_f32_32x32x16_bf16 v[32:47], v[112:115], v[16:19], 0
  v_mfma_f32_32x32x16_bf16 v[32:47], v[116:119], v[20:23], v[32:47]
  v_mfma_f32_32x32x16_bf16 v[48:63], v[112:115], v[24:27], 0
  v_mfma_f32_32x32x16_bf16 v[48:63], v[116:119], v[28:31], v[48:63]
  s_nop 9
  v_max3_f32 v3, v3, v32, v33
  v_max3_f32 v3, v3, v34, v35
  v_max3_f32 v3, v3, v36, v37
  v_max3_f32 v3, v3, v38, v39
  v_max3_f32 v3, v3, v40, v41
  v_max3_f32 v3, v3, v42, v43
  v_max3_f32 v3, v3, v44, v45
  v_max3_f32 v3, v3, v46, v47
  v_max3_f32 v5, v5, v48, v49
  v_max3_f32 v5, v5, v50, v51
  v_max3_f32 v5, v5, v52, v53
  v_max3_f32 v5, v5, v54, v55
  v_max3_f32 v5, v5, v56, v57
  v_max3_f32 v5, v5, v58, v59
  v_max3_f32 v5, v5, v60, v61
  v_max3_f32 v5, v5, v62, v63
  s_add_u32 s41, s41, 3072
  s_cmp_lt_u32 s41, 196608
  s_cbranch_scc1 parallel_sum__grouped_kv_mqa__swiglu_ffn__prompt_kernel_sl163
  v_mov_b32 v15, v3
  s_nop 1
  v_permlane32_swap_b32 v3, v15
  v_max_f32 v3, v3, v15
  v_cvt_pk_bf16_f32 v15, 0, -v3
  v_cmp_ne_u32 vcc, 0, v6
  v_sub_f32 v3, -v3, v15
  v_cvt_pk_bf16_f32 v3, v3, v15
  v_cndmask_b32 v22, v3, 0, vcc
  v_mov_b32 v15, v5
  s_nop 1
  v_permlane32_swap_b32 v5, v15
  v_max_f32 v5, v5, v15
  v_cvt_pk_bf16_f32 v15, 0, -v5
  v_cmp_ne_u32 vcc, 0, v6
  v_sub_f32 v5, -v5, v15
  v_cvt_pk_bf16_f32 v5, v5, v15
  v_cndmask_b32 v30, v5, 0, vcc
  v_mov_b32 v144, 0
  v_mov_b32 v145, 0
  v_mov_b32 v146, 0
  v_mov_b32 v147, 0
  v_mov_b32 v148, 0
  v_mov_b32 v149, 0
  v_mov_b32 v150, 0
  v_mov_b32 v151, 0
  v_mov_b32 v152, 0
  v_mov_b32 v153, 0
  v_mov_b32 v154, 0
  v_mov_b32 v155, 0
  v_mov_b32 v156, 0
  v_mov_b32 v157, 0
  v_mov_b32 v158, 0
  v_mov_b32 v159, 0
  v_mov_b32 v160, 0
  v_mov_b32 v161, 0
  v_mov_b32 v162, 0
  v_mov_b32 v163, 0
  v_mov_b32 v164, 0
  v_mov_b32 v165, 0
  v_mov_b32 v166, 0
  v_mov_b32 v167, 0
  v_mov_b32 v168, 0
  v_mov_b32 v169, 0
  v_mov_b32 v170, 0
  v_mov_b32 v171, 0
  v_mov_b32 v172, 0
  v_mov_b32 v173, 0
  v_mov_b32 v174, 0
  v_mov_b32 v175, 0
  s_mov_b32 s41, 0
parallel_sum__grouped_kv_mqa__swiglu_ffn__prompt_kernel_sl264:
  buffer_load_dwordx4 v[112:115], v2, s[24:27], s41 offen sc1
  buffer_load_dwordx2 v[116:117], v11, s[24:27], s41 offen sc1
  buffer_load_dwordx4 v[120:123], v12, s[24:27], s41 offen sc1
  buffer_load_dwordx4 v[124:127], v12, s[24:27], s41 offen offset:768 sc1
  s_waitcnt vmcnt(0)
  v_mfma_f32_32x32x16_bf16 v[32:47], v[112:115], v[16:19], 0
  v_mfma_f32_32x32x16_bf16 v[32:47], v[116:119], v[20:23], v[32:47]
  v_mfma_f32_32x32x16_bf16 v[48:63], v[112:115], v[24:27], 0
  v_mfma_f32_32x32x16_bf16 v[48:63], v[116:119], v[28:31], v[48:63]
  s_nop 9
  v_exp_f32 v32, v32
  v_exp_f32 v33, v33
  v_exp_f32 v34, v34
  v_exp_f32 v35, v35
  v_exp_f32 v36, v36
  v_exp_f32 v37, v37
  v_exp_f32 v38, v38
  v_exp_f32 v39, v39
  v_exp_f32 v40, v40
  v_exp_f32 v41, v41
  v_exp_f32 v42, v42
  v_exp_f32 v43, v43
  v_exp_f32 v44, v44
  v_exp_f32 v45, v45
  v_exp_f32 v46, v46
  v_exp_f32 v47, v47
  v_cvt_pk_bf16_f32 v96, v32, v33
  v_cvt_pk_bf16_f32 v97, v34, v35
  v_cvt_pk_bf16_f32 v98, v36, v37
  v_cvt_pk_bf16_f32 v99, v38, v39
  v_cvt_pk_bf16_f32 v100, v40, v41
  v_cvt_pk_bf16_f32 v101, v42, v43
  v_cvt_pk_bf16_f32 v102, v44, v45
  v_cvt_pk_bf16_f32 v103, v46, v47
  v_mfma_f32_32x32x16_bf16 v[144:159], v[120:123], v[96:99], v[144:159]
  s_nop 0
  v_mfma_f32_32x32x16_bf16 v[144:159], v[124:127], v[100:103], v[144:159]
  v_exp_f32 v48, v48
  v_exp_f32 v49, v49
  v_exp_f32 v50, v50
  v_exp_f32 v51, v51
  v_exp_f32 v52, v52
  v_exp_f32 v53, v53
  v_exp_f32 v54, v54
  v_exp_f32 v55, v55
  v_exp_f32 v56, v56
  v_exp_f32 v57, v57
  v_exp_f32 v58, v58
  v_exp_f32 v59, v59
  v_exp_f32 v60, v60
  v_exp_f32 v61, v61
  v_exp_f32 v62, v62
  v_exp_f32 v63, v63
  v_cvt_pk_bf16_f32 v104, v48, v49
  v_cvt_pk_bf16_f32 v105, v50, v51
  v_cvt_pk_bf16_f32 v106, v52, v53
  v_cvt_pk_bf16_f32 v107, v54, v55
  v_cvt_pk_bf16_f32 v108, v56, v57
  v_cvt_pk_bf16_f32 v109, v58, v59
  v_cvt_pk_bf16_f32 v110, v60, v61
  v_cvt_pk_bf16_f32 v111, v62, v63
  v_mfma_f32_32x32x16_bf16 v[160:175], v[120:123], v[104:107], v[160:175]
  s_nop 0
  v_mfma_f32_32x32x16_bf16 v[160:175], v[124:127], v[108:111], v[160:175]
  s_add_u32 s41, s41, 3072
  s_cmp_lt_u32 s41, 196608
  s_cbranch_scc1 parallel_sum__grouped_kv_mqa__swiglu_ffn__prompt_kernel_sl264
  s_nop 12
  s_branch parallel_sum__grouped_kv_mqa__swiglu_ffn__prompt_kernel_out54
parallel_sum__grouped_kv_mqa__swiglu_ffn__prompt_kernel_end:

.section .rodata,"a"
.p2align 6
.amdhsa_kernel parallel_sum__grouped_kv_mqa__swiglu_ffn__prompt_kernel
  .amdhsa_next_free_vgpr 256
  .amdhsa_next_free_sgpr 76
  .amdhsa_accum_offset 256
  .amdhsa_group_segment_fixed_size 0
  .amdhsa_kernarg_size 96
  .amdhsa_user_sgpr_count 2
  .amdhsa_user_sgpr_kernarg_segment_ptr 1
  .amdhsa_system_sgpr_workgroup_id_x 1
  .amdhsa_float_denorm_mode_32 3
.end_amdhsa_kernel
```
